```python
import torch

def _softmax(x, axis=-1):
    return torch.softmax(x, dim=axis)
def _gelu(x):
    return torch.nn.functional.gelu(x, approximate="tanh")
def _silu(x):
    return torch.nn.functional.silu(x)
def _sigmoid(x):
    return torch.sigmoid(x)
def _layernorm(x, axis=-1, eps=1e-5):
    m = x.mean(dim=axis, keepdim=True)
    v = x.var(dim=axis, keepdim=True, unbiased=False)
    return (x - m) / torch.sqrt(v + eps)
def _scatter_add(tgt, idx, src, axis=0):
    return tgt.clone().index_add_(axis, idx, src)
def _segment_sum(src, seg, n):
    out = torch.zeros((n,) + src.shape[1:], dtype=src.dtype)
    return out.index_add_(0, seg, src)
def _pad(x, pw):
    flat = tuple(v for pair in reversed(pw) for v in pair)
    return torch.nn.functional.pad(x, flat)

kernel_name = 'sequential_preLN__ssm_conv_h3__dense_activation_silu__prompt'

def setup_inputs():

    _w = (lambda a: (lambda t: t.to(torch.bfloat16) if t.is_floating_point() else t)(torch.as_tensor(a)))
    def _A_setup():
        B, S, D = 1, 2048, 512
        ks = 4
        return {
            "q": _w((lambda *s: torch.randn(*s, dtype=torch.bfloat16) * 0.05)(B, S, D)),
            "k": _w((lambda *s: torch.randn(*s, dtype=torch.bfloat16) * 0.2)(B, S, D)),
            "v": _w((lambda *s: torch.randn(*s, dtype=torch.bfloat16) * 0.2)(B, S, D)),
            "shift_k": _w((lambda *s: torch.randn(*s, dtype=torch.bfloat16) * 0.2)(D, ks) * 0.5),
            "ssm_k": _w((lambda *s: torch.randn(*s, dtype=torch.bfloat16) * 0.8)(D, S) * (1.0 / S ** 0.5)),
            "ssm_D": _w((lambda *s: torch.randn(*s, dtype=torch.bfloat16) * 0.2)(D)),
        }
    _A_in = _A_setup()

    def _B_setup():
        B, S, D, F = 1, 2048, 512, 1376
        return {
            "x": _w((lambda *s: torch.randn(*s, dtype=torch.bfloat16) * 0.05)(B, S, D)),
            "w1": _w((lambda *s: torch.randn(*s, dtype=torch.bfloat16) * 0.8)(D, F) * (D ** -0.5)),
            "w2": _w((lambda *s: torch.randn(*s, dtype=torch.bfloat16) * 0.1)(F, D) * (F ** -0.5)),
        }
    _B_in = _B_setup()

    return {
        "A_q": _A_in["q"],
        "A_k": _A_in["k"],
        "A_v": _A_in["v"],
        "A_shift_k": _A_in["shift_k"],
        "A_ssm_k": _A_in["ssm_k"],
        "A_ssm_D": _A_in["ssm_D"],
        "B_x": _B_in["x"],
        "B_w1": _B_in["w1"],
        "B_w2": _B_in["w2"],
    }

def reference(A_q, A_k, A_v, A_shift_k, A_ssm_k, A_ssm_D, B_x, B_w1, B_w2):
    def _A_ref(q, k, v, shift_k, ssm_k, ssm_D):
        B, S, D = q.shape
        ks = shift_k.shape[-1]
        k_pad = _pad(k, ((0, 0), (ks - 1, 0), (0, 0)))
        k_shift = torch.zeros_like(k)
        for t in range(ks):
            k_shift = k_shift + k_pad[:, t:t + S, :] * shift_k[:, ks - 1 - t][None, None, :]
        kv = k_shift * v
        L = 2 * S
        kv_pad = _pad(kv, ((0, 0), (0, S), (0, 0)))
        kf_pad = _pad(ssm_k, ((0, 0), (0, S)))
        kv_f = (lambda x, axes=(-2,-1): torch.fft.rfft2(x.float(), dim=axes))(kv_pad[:, None, :, :], axes=(1, 2))
        kf_f = (lambda x, axes=(-2,-1): torch.fft.rfft2(x.float(), dim=axes))(kf_pad[:, None, :], axes=(1, 2))
        kf_f = (lambda x, *d: x.permute(*d))(kf_f, 1, 2, 0)
        y_f = kv_f * kf_f[None, :, :, :]
        y = (lambda x, s, axes=(-2,-1): torch.fft.irfft2(x, s=s, dim=axes).to(torch.bfloat16))(y_f, (1, L), axes=(1, 2))[:, 0, :S, :]
        y = y + kv * ssm_D[None, None, :]
        return q * y

    def _B_ref(x, w1, w2):
        h = torch.einsum("bsd,df->bsf", x, w1)
        h = _silu(h)
        out = torch.einsum("bsf,fd->bsd", h, w2)
        return out

    x = A_q
    h = x + _A_ref(_layernorm(x, axis=-1), A_k, A_v, A_shift_k, A_ssm_k, A_ssm_D)
    h2 = h + _B_ref(_layernorm(h, axis=-1), B_w1, B_w2)
    return h2
```

```asm
; @launch grid=(256,1,1) block=(256,1,1) lds=163840
.amdgcn_target "amdgcn-amd-amdhsa--gfx950"
.text
.globl sequential_preLN__ssm_conv_h3__dense_activation_silu__prompt_kernel
.p2align 8
.type sequential_preLN__ssm_conv_h3__dense_activation_silu__prompt_kernel,@function
sequential_preLN__ssm_conv_h3__dense_activation_silu__prompt_kernel:
  s_cmp_ge_u32 s2, 256
  s_cbranch_scc1 L_end
  s_load_dwordx2 s[16:17], s[0:1], 0
  s_load_dwordx2 s[20:21], s[0:1], 8
  s_load_dwordx2 s[24:25], s[0:1], 16
  s_load_dwordx2 s[28:29], s[0:1], 24
  s_load_dwordx2 s[32:33], s[0:1], 32
  s_load_dwordx2 s[52:53], s[0:1], 40
  s_load_dwordx2 s[40:41], s[0:1], 56
  s_load_dwordx2 s[44:45], s[0:1], 64
  s_load_dwordx2 s[48:49], s[0:1], 72
  s_load_dwordx2 s[36:37], s[0:1], 88
  s_getpc_b64 s[4:5]
  s_and_b32 s4, s4, 0xffffff00

  v_lshlrev_b32 v7, 7, v0
  v_min_u32 v7, 0x4fb4, v7
  global_load_dword v49, v7, s[4:5]

  s_mov_b32 s18, 0x200000
  s_mov_b32 s19, 0x20000
  s_mov_b32 s22, 0x200000
  s_mov_b32 s23, 0x20000
  s_mov_b32 s26, 0x200000
  s_mov_b32 s27, 0x20000
  s_mov_b32 s30, 0x1000
  s_mov_b32 s31, 0x20000
  s_mov_b32 s34, 0x200000
  s_mov_b32 s35, 0x20000
  s_mov_b32 s38, 0x1000000
  s_mov_b32 s39, 0x20000
  s_mov_b32 s42, 0x158000
  s_mov_b32 s43, 0x20000
  s_mov_b32 s46, 0x158000
  s_mov_b32 s47, 0x20000
  s_mov_b32 s50, 0x200000
  s_mov_b32 s51, 0x20000
  v_lshrrev_b32 v5, 6, v0
  v_and_b32 v4, 63, v0
  s_and_b32 s62, s2, 7
  s_lshr_b32 s63, s2, 3
  v_readfirstlane_b32 s54, v5
  s_lshl_b32 s64, s62, 5
  s_add_u32 s64, s64, s63
  s_lshl_b32 s3, s64, 13
  v_lshrrev_b32 v1, 4, v4
  v_lshlrev_b32 v1, 10, v1
  v_and_b32 v2, 15, v4
  v_lshl_add_u32 v1, v2, 4, v1
  v_lshl_add_u32 v1, v5, 8, v1
  v_add_u32 v1, s3, v1
  v_add_u32 v2, 3072, v1
  v_subrev_u32 v3, 0x1000, v1
  s_mul_i32 s8, s54, 24576
  s_add_u32 s8, s8, 65536
  v_lshrrev_b32 v6, 1, v4
  v_and_b32 v6, 30, v6
  v_and_b32 v7, 1, v4
  v_add_u32 v6, v6, v7
  v_and_b32 v7, 2, v4
  v_mul_u32_u24 v7, 24, v7
  v_xor_b32 v35, v7, v6
  v_lshl_add_u32 v5, v5, 6, v35
  v_lshlrev_b32 v5, 4, v5
  v_lshlrev_b32 v255, 4, v4
  s_lshl_b32 s4, s54, 11
  s_add_u32 s4, s4, s3
  v_mov_b32 v7, 0xe90000
  s_mul_i32 s3, s64, 16512
  s_lshr_b32 s65, s62, 1
  s_lshl_b32 s65, s65, 5
  s_add_u32 s65, s65, s63
  s_and_b32 s66, s62, 1
  s_lshr_b32 s58, s54, 1
  s_and_b32 s59, s54, 1
  s_lshl_b32 s6, s65, 14
  s_lshl_b32 s5, s66, 12
  s_add_u32 s6, s6, s5
  s_lshl_b32 s5, s58, 13
  s_add_u32 s7, s6, s5
  s_lshl_b32 s5, s59, 11
  s_add_u32 s7, s7, s5
  v_lshlrev_b32 v6, 5, v4
  v_lshrrev_b32 v68, 2, v4
  v_lshlrev_b32 v68, 13, v68

  s_waitcnt lgkmcnt(0)
  s_mov_b32 m0, s8
  buffer_load_dwordx4 v[16:19], v255, s[16:19], s4 offen
  buffer_load_dwordx4 v[20:23], v255, s[16:19], s4 offen offset:1024
  buffer_load_dwordx4 v1, s[16:19], 0 offen nt lds
  buffer_load_dwordx4 v2, s[16:19], 0 offen offset:1024 nt lds

  s_add_u32 m0, s8, 2048
  buffer_load_dwordx4 v[44:47], v5, s[28:31], 0 offen
  buffer_load_dwordx4 v3, s[20:23], 0 offen lds
  s_add_u32 m0, s8, 3072
  s_nop 0
  buffer_load_dwordx4 v1, s[20:23], 0 offen nt lds
  buffer_load_dwordx4 v2, s[20:23], 0 offen offset:1024 nt lds

  s_add_u32 m0, s8, 5120
  s_nop 0
  buffer_load_dwordx4 v1, s[24:27], 0 offen nt lds
  buffer_load_dwordx4 v2, s[24:27], 0 offen offset:1024 nt lds
  v_lshlrev_b32 v35, 2, v35
  v_add_u32 v35, s8, v35
  v_xor_b32 v63, 0xc0, v35

  buffer_load_dword v48, v7, s[36:39], 0 offen sc1
  buffer_load_dwordx4 v[52:55], v6, s[32:35], s7 offen nt
  buffer_load_dwordx4 v[56:59], v6, s[32:35], s7 offen offset:16 nt
  buffer_load_dwordx2 v[60:61], v6, s[32:35], s7 offen offset:32 nt
  s_mov_b64 exec, 0xff
  buffer_load_dwordx2 v[50:51], v68, s[32:35], s6 offen
  s_mov_b64 exec, -1

  s_mov_b32 s10, s6
  s_mov_b32 s12, s7
  s_mul_i32 s6, s58, 16640
  s_add_u32 s6, s6, s5
  s_add_u32 s6, s6, 32
  v_add_u32 v69, s6, v6
  s_lshl_b32 s67, s65, 1
  s_add_u32 s67, s67, s66
  s_lshl_b32 s68, s62, 2
  s_lshr_b32 s69, s63, 3
  s_add_u32 s68, s68, s69
  s_and_b32 s69, s63, 7
  s_lshl_b32 s60, s65, 3
  s_load_dwordx2 s[14:15], s[52:53], s60
  v_and_b32 v254, 15, v4
  v_lshrrev_b32 v253, 4, v4
  s_lshl_b32 s56, s68, 3
  s_add_u32 s56, s56, s69
  v_mov_b32 v7, s64
  v_mov_b32 v6, s67
  v_cmp_gt_u32 vcc, 8, v4
  v_mov_b32 v64, 0
  v_mov_b32 v65, 0
  v_cndmask_b32 v7, v6, v7, vcc
  s_lshl_b32 s6, s56, 1
  v_mov_b32 v6, s6
  v_cmp_gt_u32 vcc, 16, v4
  v_mov_b32 v66, 0
  v_mov_b32 v67, 0
  v_cndmask_b32 v7, v6, v7, vcc
  v_lshlrev_b32 v7, 6, v7
  v_lshl_add_u32 v7, v4, 15, v7
  s_mov_b32 s6, 0xe00000
  s_cmp_lg_u32 s54, 0
  s_cselect_b32 exec_lo, 1, 0x3ffff
  s_mov_b32 exec_hi, 0
  buffer_load_dword v49, v7, s[36:39], s6 offen sc1
  s_mov_b64 exec, -1
  v_lshlrev_b32 v1, 3, v0
  ds_write_b64 v1, v[64:65] offset:33280
  v_mul_u32_u24 v70, 4160, v4
  v_and_b32 v71, 3, v4
  v_lshlrev_b32 v71, 4, v71
  v_sub_u32 v71, 48, v71
  s_lshl_b32 s11, s64, 6
  s_lshl_b32 s13, s54, 4
  s_add_u32 s11, s11, s13
  s_add_u32 s11, s11, 0x500000
  v_lshlrev_b32 v62, 3, v253

  v_and_b32 v248, 3, v4
  v_mul_u32_u24 v248, 4160, v248
  v_lshrrev_b32 v6, 2, v254
  v_lshl_add_u32 v248, v6, 3, v248
  v_lshl_add_u32 v248, v253, 4, v248
  s_mul_i32 s6, s58, 16640
  s_lshl_b32 s7, s59, 8
  s_add_u32 s6, s6, s7
  v_add_u32 v248, s6, v248
  v_lshlrev_b32 v1, 1, v254
  v_sub_u32 v1, v1, v253
  s_lshl_b32 s7, s59, 4
  s_sub_u32 s7, 33, s7
  v_add_u32 v1, s7, v1

  v_subrev_u32 v2, 0, v1
  v_bfe_u32 v3, v2, 2, 2
  v_xor_b32 v3, s58, v3
  v_lshlrev_b32 v2, 6, v2
  v_lshl_add_u32 v240, v3, 4, v2

  v_subrev_u32 v2, 4, v1
  v_bfe_u32 v3, v2, 2, 2
  v_xor_b32 v3, s58, v3
  v_lshlrev_b32 v2, 6, v2
  v_lshl_add_u32 v241, v3, 4, v2

  v_subrev_u32 v2, 8, v1
  v_bfe_u32 v3, v2, 2, 2
  v_xor_b32 v3, s58, v3
  v_lshlrev_b32 v2, 6, v2
  v_lshl_add_u32 v242, v3, 4, v2

  v_subrev_u32 v2, 12, v1
  v_bfe_u32 v3, v2, 2, 2
  v_xor_b32 v3, s58, v3
  v_lshlrev_b32 v2, 6, v2
  v_lshl_add_u32 v243, v3, 4, v2

  s_mul_i32 s4, s69, 352
  s_mul_i32 s5, s54, 96
  s_add_u32 s4, s4, s5
  s_cmp_eq_u32 s69, 7
  s_cselect_b32 s6, 0, 64
  s_add_u32 s6, s6, 288
  s_sub_u32 s6, s6, s5
  s_mov_b32 s7, 0x2aaaaaab
  v_mov_b32 v1, 0x7fffffff

  v_add_u32 v3, 0, v4
  v_mul_hi_u32 v7, v3, s7
  v_mul_u32_u24 v2, 6, v7
  v_sub_u32 v2, v3, v2
  v_lshlrev_b32 v2, 4, v2
  v_cmp_gt_i32 vcc, s6, v2
  v_mul_u32_u24 v7, 2752, v7
  v_add3_u32 v7, v7, v2, s4
  v_subrev_u32 v7, 0, v7
  v_cndmask_b32 v250, v1, v7, vcc

  v_add_u32 v3, 64, v4
  v_mul_hi_u32 v7, v3, s7
  v_mul_u32_u24 v2, 6, v7
  v_sub_u32 v2, v3, v2
  v_lshlrev_b32 v2, 4, v2
  v_cmp_gt_i32 vcc, s6, v2
  v_mul_u32_u24 v7, 2752, v7
  v_add3_u32 v7, v7, v2, s4
  v_subrev_u32 v7, 1024, v7
  v_cndmask_b32 v251, v1, v7, vcc

  v_add_u32 v3, 128, v4
  v_mul_hi_u32 v7, v3, s7
  v_mul_u32_u24 v2, 6, v7
  v_sub_u32 v2, v3, v2
  v_lshlrev_b32 v2, 4, v2
  v_cmp_gt_i32 vcc, s6, v2
  v_mul_u32_u24 v7, 2752, v7
  v_add3_u32 v7, v7, v2, s4
  v_subrev_u32 v7, 2048, v7
  v_cndmask_b32 v252, v1, v7, vcc

  s_mov_b32 s4, 0x3f803f80
  s_mov_b32 s5, 0x05040100
  s_mov_b32 s6, 0x07060302
  s_mov_b32 s9, 0xffff0000

  s_waitcnt vmcnt(12)
  ds_read2st64_b32 v[8:9], v63 offset0:0 offset1:1
  ds_read2st64_b32 v[10:11], v63 offset0:2 offset1:3
  ds_read2st64_b32 v[12:13], v63 offset0:4 offset1:5
  ds_read2st64_b32 v[14:15], v63 offset0:6 offset1:7
  v_dot2_f32_bf16 v72, v16, s4, 0
  v_dot2_f32_bf16 v73, v16, v16, 0
  v_dot2_f32_bf16 v74, v20, s4, 0
  v_dot2_f32_bf16 v75, v20, v20, 0
  v_dot2_f32_bf16 v72, v17, s4, v72
  v_dot2_f32_bf16 v73, v17, v17, v73
  v_dot2_f32_bf16 v74, v21, s4, v74
  v_dot2_f32_bf16 v75, v21, v21, v75
  v_dot2_f32_bf16 v72, v18, s4, v72
  v_dot2_f32_bf16 v73, v18, v18, v73
  v_dot2_f32_bf16 v74, v22, s4, v74
  v_dot2_f32_bf16 v75, v22, v22, v75
  v_dot2_f32_bf16 v72, v19, s4, v72
  v_dot2_f32_bf16 v73, v19, v19, v73
  v_dot2_f32_bf16 v74, v23, s4, v74
  v_dot2_f32_bf16 v75, v23, v23, v75
  s_waitcnt vmcnt(8)
  ds_read2st64_b32 v[24:25], v35 offset0:9 offset1:10
  ds_read2st64_b32 v[26:27], v35 offset0:11 offset1:12
  ds_read2st64_b32 v[28:29], v35 offset0:13 offset1:14
  ds_read2st64_b32 v[30:31], v35 offset0:15 offset1:16
  ds_read2st64_b32 v[32:33], v35 offset0:17 offset1:18
  ds_read_b32 v34, v35 offset:4864
  s_waitcnt lgkmcnt(0)
  v_perm_b32 v76, v9, v8, s5
  v_perm_b32 v80, v9, v8, s6
  v_perm_b32 v77, v11, v10, s5
  v_perm_b32 v81, v11, v10, s6
  v_perm_b32 v78, v13, v12, s5
  v_perm_b32 v82, v13, v12, s6
  v_perm_b32 v79, v15, v14, s5
  v_perm_b32 v83, v15, v14, s6
  v_permlane32_swap_b32 v72, v73
  v_permlane32_swap_b32 v74, v75
  v_add_f32 v72, v72, v73
  v_add_f32 v74, v74, v75
  v_lshlrev_b32 v84, 16, v24
  v_and_b32 v85, s9, v24
  v_permlane16_swap_b32 v72, v74
  v_add_f32 v72, v72, v74
  v_lshlrev_b32 v86, 16, v25
  v_and_b32 v87, s9, v25
  v_add_f32_dpp v72, v72, v72 row_ror:8 row_mask:0xf bank_mask:0xf
  v_lshlrev_b32 v88, 16, v26
  v_and_b32 v89, s9, v26
  v_add_f32_dpp v72, v72, v72 row_ror:4 row_mask:0xf bank_mask:0xf
  v_lshlrev_b32 v90, 16, v27
  v_and_b32 v91, s9, v27
  v_add_f32_dpp v72, v72, v72 row_ror:2 row_mask:0xf bank_mask:0xf
  v_lshlrev_b32 v92, 16, v28
  v_and_b32 v93, s9, v28
  v_add_f32_dpp v72, v72, v72 row_ror:1 row_mask:0xf bank_mask:0xf
  v_mul_f32 v73, 0x3b000000, v72
  v_mul_f32 v72, 0x3b000000, v72
  v_lshlrev_b32 v94, 16, v29
  v_and_b32 v95, s9, v29
  v_permlane32_swap_b32 v73, v72
  v_fma_f32 v72, -v73, v73, v72
  v_max_f32 v72, 0, v72
  v_add_f32 v72, 0x3727c5ac, v72
  v_rsq_f32 v72, v72
  v_lshlrev_b32 v96, 16, v30
  v_and_b32 v97, s9, v30
  v_mul_f32_e64 v73, -v73, v72
  s_mov_b64 exec, 0x10001
  buffer_store_dwordx2 v[72:73], v62, s[36:39], s11 offen sc1
  s_mov_b64 exec, -1
  v_lshlrev_b32 v98, 16, v31
  v_and_b32 v99, s9, v31
  s_waitcnt vmcnt(7)
  ds_read2st64_b32 v[36:37], v35 offset0:20 offset1:21
  ds_read2st64_b32 v[38:39], v35 offset0:22 offset1:23
  ds_read2st64_b32 v[40:41], v35 offset0:24 offset1:25
  ds_read2st64_b32 v[42:43], v35 offset0:26 offset1:27
  v_lshlrev_b32 v100, 16, v32
  v_and_b32 v101, s9, v32
  v_lshlrev_b32 v102, 16, v33
  v_and_b32 v103, s9, v33
  v_lshlrev_b32 v104, 16, v34
  v_and_b32 v105, s9, v34
  v_lshlrev_b32 v106, 16, v44
  v_and_b32 v108, s9, v44
  v_lshlrev_b32 v110, 16, v45
  v_and_b32 v112, s9, v45
  v_lshlrev_b32 v107, 16, v46
  v_and_b32 v109, s9, v46
  v_lshlrev_b32 v111, 16, v47
  v_and_b32 v113, s9, v47
  v_pk_mul_f32 v[114:115], v[84:85], v[112:113]
  v_pk_mul_f32 v[116:117], v[86:87], v[112:113]
  v_pk_mul_f32 v[118:119], v[88:89], v[112:113]
  v_pk_mul_f32 v[120:121], v[90:91], v[112:113]
  v_pk_mul_f32 v[122:123], v[92:93], v[112:113]
  v_pk_mul_f32 v[124:125], v[94:95], v[112:113]
  v_pk_mul_f32 v[126:127], v[96:97], v[112:113]
  v_pk_mul_f32 v[128:129], v[98:99], v[112:113]
  v_pk_fma_f32 v[114:115], v[86:87], v[110:111], v[114:115]
  v_pk_fma_f32 v[116:117], v[88:89], v[110:111], v[116:117]
  v_pk_fma_f32 v[118:119], v[90:91], v[110:111], v[118:119]
  v_pk_fma_f32 v[120:121], v[92:93], v[110:111], v[120:121]
  v_pk_fma_f32 v[122:123], v[94:95], v[110:111], v[122:123]
  v_pk_fma_f32 v[124:125], v[96:97], v[110:111], v[124:125]
  v_pk_fma_f32 v[126:127], v[98:99], v[110:111], v[126:127]
  v_pk_fma_f32 v[128:129], v[100:101], v[110:111], v[128:129]
  v_pk_fma_f32 v[114:115], v[88:89], v[108:109], v[114:115]
  v_pk_fma_f32 v[116:117], v[90:91], v[108:109], v[116:117]
  v_pk_fma_f32 v[118:119], v[92:93], v[108:109], v[118:119]
  v_pk_fma_f32 v[120:121], v[94:95], v[108:109], v[120:121]
  v_pk_fma_f32 v[122:123], v[96:97], v[108:109], v[122:123]
  v_pk_fma_f32 v[124:125], v[98:99], v[108:109], v[124:125]
  v_pk_fma_f32 v[126:127], v[100:101], v[108:109], v[126:127]
  v_pk_fma_f32 v[128:129], v[102:103], v[108:109], v[128:129]
  v_pk_fma_f32 v[114:115], v[90:91], v[106:107], v[114:115]
  v_pk_fma_f32 v[116:117], v[92:93], v[106:107], v[116:117]
  v_pk_fma_f32 v[118:119], v[94:95], v[106:107], v[118:119]
  v_pk_fma_f32 v[120:121], v[96:97], v[106:107], v[120:121]
  v_pk_fma_f32 v[122:123], v[98:99], v[106:107], v[122:123]
  v_pk_fma_f32 v[124:125], v[100:101], v[106:107], v[124:125]
  v_pk_fma_f32 v[126:127], v[102:103], v[106:107], v[126:127]
  v_pk_fma_f32 v[128:129], v[104:105], v[106:107], v[128:129]
  s_waitcnt lgkmcnt(0)
  v_lshlrev_b32 v130, 16, v36
  v_and_b32 v131, s9, v36
  v_lshlrev_b32 v132, 16, v37
  v_and_b32 v133, s9, v37
  v_lshlrev_b32 v134, 16, v38
  v_and_b32 v135, s9, v38
  v_lshlrev_b32 v136, 16, v39
  v_and_b32 v137, s9, v39
  v_lshlrev_b32 v138, 16, v40
  v_and_b32 v139, s9, v40
  v_lshlrev_b32 v140, 16, v41
  v_and_b32 v141, s9, v41
  v_lshlrev_b32 v142, 16, v42
  v_and_b32 v143, s9, v42
  v_lshlrev_b32 v144, 16, v43
  v_and_b32 v145, s9, v43
  v_pk_mul_f32 v[114:115], v[114:115], v[130:131]
  v_pk_mul_f32 v[116:117], v[116:117], v[132:133]
  v_pk_mul_f32 v[118:119], v[118:119], v[134:135]
  v_pk_mul_f32 v[120:121], v[120:121], v[136:137]
  v_pk_mul_f32 v[122:123], v[122:123], v[138:139]
  v_pk_mul_f32 v[124:125], v[124:125], v[140:141]
  v_pk_mul_f32 v[126:127], v[126:127], v[142:143]
  v_pk_mul_f32 v[128:129], v[128:129], v[144:145]
  v_cvt_pk_bf16_f32 v148, v128, v126
  v_cvt_pk_bf16_f32 v152, v129, v127
  v_cvt_pk_bf16_f32 v149, v124, v122
  v_cvt_pk_bf16_f32 v153, v125, v123
  v_cvt_pk_bf16_f32 v150, v120, v118
  v_cvt_pk_bf16_f32 v154, v121, v119
  v_cvt_pk_bf16_f32 v151, v116, v114
  v_cvt_pk_bf16_f32 v155, v117, v115
  s_lshl_b32 s4, s54, 11
  s_add_u32 s4, s4, s3
  s_add_u32 s5, s4, 8192
  s_mov_b32 exec_lo, 0xcccccccc
  s_mov_b32 exec_hi, 0xcccccccc

  v_swap_b32 v148, v76
  v_swap_b32 v149, v77
  v_swap_b32 v150, v78
  v_swap_b32 v151, v79
  v_swap_b32 v152, v80
  v_swap_b32 v153, v81
  v_swap_b32 v154, v82
  v_swap_b32 v155, v83
  s_mov_b64 exec, -1
  buffer_store_dwordx4 v[148:151], v255, s[36:39], s4 offen sc1
  buffer_store_dwordx4 v[76:79], v255, s[36:39], s4 offen offset:1024 sc1
  buffer_store_dwordx4 v[152:155], v255, s[36:39], s5 offen sc1
  buffer_store_dwordx4 v[80:83], v255, s[36:39], s5 offen offset:1024 sc1

  s_waitcnt vmcnt(6)
  v_readfirstlane_b32 s55, v48
  s_waitcnt lgkmcnt(0)
  s_cmp_eq_u32 s58, 0
  s_cselect_b32 s14, s14, s15
  s_lshl_b32 s15, s14, 16
  s_and_b32 s14, s14, 0xffff0000
  s_cmp_eq_u32 s66, 0
  s_cselect_b32 s53, s15, s14
  s_mul_i32 s55, s55, 0x9e3779b1
  s_add_u32 s55, s55, 0x7f4a7c15

  v_alignbit_b32 v160, v53, v52, 16
  v_alignbit_b32 v161, v54, v53, 16
  v_alignbit_b32 v162, v55, v54, 16
  v_alignbit_b32 v163, v56, v55, 16
  v_alignbit_b32 v164, v57, v56, 16
  v_alignbit_b32 v165, v58, v57, 16
  v_alignbit_b32 v166, v59, v58, 16
  v_alignbit_b32 v167, v60, v59, 16
  v_alignbit_b32 v168, v61, v60, 16
  v_mov_b32 v172, v53
  v_mov_b32 v173, v54
  v_mov_b32 v174, v55
  v_mov_b32 v175, v56
  v_mov_b32 v176, v57
  v_mov_b32 v177, v58
  v_mov_b32 v178, v59
  v_mov_b32 v179, v60
  v_mov_b32 v180, v161
  v_mov_b32 v181, v162
  v_mov_b32 v182, v163
  v_mov_b32 v183, v164
  v_mov_b32 v184, v165
  v_mov_b32 v185, v166
  v_mov_b32 v186, v167
  v_mov_b32 v187, v168
  ds_write_b128 v69, v[160:163] offset:0
  ds_write_b128 v69, v[164:167] offset:16
  ds_write_b128 v69, v[172:175] offset:4160
  ds_write_b128 v69, v[176:179] offset:4176
  ds_write_b128 v69, v[180:183] offset:8320
  ds_write_b128 v69, v[184:187] offset:8336
  ds_write_b128 v69, v[54:57] offset:12480
  ds_write_b128 v69, v[58:61] offset:12496
  s_cmp_lg_u32 s54, 1
  s_cbranch_scc1 L_nopatch
  s_mov_b64 exec, 0xff
  v_lshlrev_b64 v[50:51], v71, v[50:51]
  ds_write_b128 v70, v[64:67] offset:0
  ds_write_b64 v70, v[64:65] offset:16
  ds_write_b64 v70, v[50:51] offset:24
  s_mov_b64 exec, -1
L_nopatch:

  s_lshl_b32 s61, s64, 6
  s_add_u32 s61, s61, 0xe00000
  v_mov_b32 v3, s55
  v_lshlrev_b32 v2, 15, v4

  s_waitcnt vmcnt(0)
  s_waitcnt lgkmcnt(0)
  s_cmp_lg_u32 s54, 0
  s_barrier
  s_cbranch_scc1 L_nofl_1
  s_mov_b64 exec, 255
  buffer_store_dword v3, v2, s[36:39], s61 offen sc1

  s_mov_b64 exec, -1
L_nofl_1:
  s_lshl_b32 s4, s2, 2
  s_add_u32 s4, s4, s54
  s_mul_i32 s4, s4, 1408
  v_lshlrev_b32 v1, 7, v4
  s_mov_b64 exec, 0x7ff
  buffer_load_dword v199, v1, s[40:43], s4 offen
  buffer_load_dword v199, v1, s[44:47], s4 offen
  s_mov_b64 exec, -1

  s_add_u32 m0, s8, 0
  s_mov_b32 s60, 0
  buffer_load_dwordx4 v250, s[40:43], s60 offen lds
  buffer_load_dwordx4 v251, s[40:43], s60 offen offset:1024 lds
  buffer_load_dwordx4 v252, s[40:43], s60 offen offset:2048 lds
  s_add_u32 m0, s8, 3072
  s_mov_b32 s60, 88064
  buffer_load_dwordx4 v250, s[40:43], s60 offen lds
  buffer_load_dwordx4 v251, s[40:43], s60 offen offset:1024 lds
  buffer_load_dwordx4 v252, s[40:43], s60 offen offset:2048 lds
  s_add_u32 m0, s8, 6144
  s_mov_b32 s60, 176128
  buffer_load_dwordx4 v250, s[40:43], s60 offen lds
  buffer_load_dwordx4 v251, s[40:43], s60 offen offset:1024 lds
  buffer_load_dwordx4 v252, s[40:43], s60 offen offset:2048 lds
  s_add_u32 m0, s8, 9216
  s_mov_b32 s60, 264192
  buffer_load_dwordx4 v250, s[40:43], s60 offen lds
  buffer_load_dwordx4 v251, s[40:43], s60 offen offset:1024 lds
  buffer_load_dwordx4 v252, s[40:43], s60 offen offset:2048 lds
  ds_read_b64 v[8:9], v248 offset:0
  ds_read_b64 v[10:11], v248 offset:8
  ds_read_b64 v[12:13], v248 offset:512
  ds_read_b64 v[14:15], v248 offset:520
  ds_read_b64 v[16:17], v248 offset:1024
  ds_read_b64 v[18:19], v248 offset:1032
  ds_read_b64 v[20:21], v248 offset:1536
  ds_read_b64 v[22:23], v248 offset:1544
  ds_read_b64 v[24:25], v248 offset:2048
  ds_read_b64 v[26:27], v248 offset:2056
  ds_read_b64 v[28:29], v248 offset:2560
  ds_read_b64 v[30:31], v248 offset:2568
  ds_read_b64 v[32:33], v248 offset:3072
  ds_read_b64 v[34:35], v248 offset:3080
  ds_read_b64 v[36:37], v248 offset:3584
  ds_read_b64 v[38:39], v248 offset:3592
  ds_read_b64 v[40:41], v248 offset:64
  ds_read_b64 v[42:43], v248 offset:72
  ds_read_b64 v[44:45], v248 offset:576
  ds_read_b64 v[46:47], v248 offset:584
  ds_read_b64 v[48:49], v248 offset:1088
  ds_read_b64 v[50:51], v248 offset:1096
  ds_read_b64 v[52:53], v248 offset:1600
  ds_read_b64 v[54:55], v248 offset:1608
  ds_read_b64 v[56:57], v248 offset:2112
  ds_read_b64 v[58:59], v248 offset:2120
  ds_read_b64 v[60:61], v248 offset:2624
  ds_read_b64 v[62:63], v248 offset:2632
  ds_read_b64 v[64:65], v248 offset:3136
  ds_read_b64 v[66:67], v248 offset:3144
  ds_read_b64 v[68:69], v248 offset:3648
  ds_read_b64 v[70:71], v248 offset:3656
  ds_read_b64 a[192:193], v248 offset:128
  ds_read_b64 a[194:195], v248 offset:136
  ds_read_b64 a[196:197], v248 offset:640
  ds_read_b64 a[198:199], v248 offset:648
  ds_read_b64 a[200:201], v248 offset:1152
  ds_read_b64 a[202:203], v248 offset:1160
  ds_read_b64 a[204:205], v248 offset:1664
  ds_read_b64 a[206:207], v248 offset:1672
  ds_read_b64 a[208:209], v248 offset:2176
  ds_read_b64 a[210:211], v248 offset:2184
  ds_read_b64 a[212:213], v248 offset:2688
  ds_read_b64 a[214:215], v248 offset:2696
  ds_read_b64 a[216:217], v248 offset:3200
  ds_read_b64 a[218:219], v248 offset:3208
  ds_read_b64 a[220:221], v248 offset:3712
  ds_read_b64 a[222:223], v248 offset:3720
  ds_read_b64 a[224:225], v248 offset:192
  ds_read_b64 a[226:227], v248 offset:200
  ds_read_b64 a[228:229], v248 offset:704
  ds_read_b64 a[230:231], v248 offset:712
  ds_read_b64 a[232:233], v248 offset:1216
  ds_read_b64 a[234:235], v248 offset:1224
  ds_read_b64 a[236:237], v248 offset:1728
  ds_read_b64 a[238:239], v248 offset:1736
  ds_read_b64 a[240:241], v248 offset:2240
  ds_read_b64 a[242:243], v248 offset:2248
  ds_read_b64 a[244:245], v248 offset:2752
  ds_read_b64 a[246:247], v248 offset:2760
  ds_read_b64 a[248:249], v248 offset:3264
  ds_read_b64 a[250:251], v248 offset:3272
  ds_read_b64 a[252:253], v248 offset:3776
  ds_read_b64 a[254:255], v248 offset:3784
  s_lshl_b32 s6, s54, 12
  v_add_u32 v247, s6, v255
  v_lshrrev_b32 v6, 2, v254
  v_lshlrev_b32 v246, 1, v254
  v_lshrrev_b32 v2, 1, v253
  v_add_u32 v246, v246, v2
  v_lshlrev_b32 v246, 6, v246
  v_and_b32 v2, 1, v253
  v_lshl_add_u32 v246, v2, 3, v246
  v_bfe_u32 v1, v254, 1, 2
  s_add_u32 s5, s58, 2
  v_xor_b32 v1, s5, v1
  v_lshl_add_u32 v246, v1, 4, v246
  s_lshl_b32 s5, s59, 11
  v_add_u32 v246, s5, v246
  v_lshrrev_b32 v1, 1, v254
  v_lshlrev_b32 v3, 1, v253
  v_xor_b32 v1, v1, v3
  v_lshl_add_u32 v1, v254, 3, v1
  v_lshlrev_b32 v245, 4, v1
  s_lshl_b32 s5, s59, 11
  v_add_u32 v245, s5, v245
  s_lshl_b32 s5, s59, 1
  s_sub_u32 s5, 3, s5
  v_mul_u32_u24 v244, s5, v2
  v_add_u32 v244, s59, v244
  v_lshlrev_b32 v244, 2, v244
  v_add_u32 v244, v244, v6
  v_lshlrev_b32 v244, 16, v244
  v_and_b32 v2, 1, v254
  v_lshl_add_u32 v244, v2, 5, v244
  v_and_b32 v2, 2, v254
  v_lshl_add_u32 v244, v2, 14, v244
  v_and_b32 v1, 2, v253
  v_lshl_add_u32 v244, v1, 3, v244
  s_lshl_b32 s12, s65, 8
  s_lshl_b32 s13, s66, 7
  s_add_u32 s12, s12, s13
  s_lshl_b32 s13, s58, 6
  s_add_u32 s12, s12, s13
  s_add_u32 s12, s12, 0x520000
  v_xor_b32 v200, 0x800, v246
  v_xor_b32 v201, 40, v246
  v_xor_b32 v202, 40, v200
  v_xor_b32 v203, 0x1000, v247
  v_xor_b32 v204, 16, v245
  v_xor_b32 v205, 0x800, v245
  v_xor_b32 v206, 16, v205
  v_lshrrev_b32 v239, 2, v4
  v_mul_u32_u24 v239, 16512, v239
  v_xor_b32 v1, v4, v253
  s_lshr_b32 s5, s65, 3
  s_and_b32 s5, s5, 2
  v_xor_b32 v2, s5, v1
  v_and_b32 v2, 3, v2
  v_lshl_add_u32 v239, v2, 4, v239
  v_lshlrev_b32 v238, 6, v0
  v_lshlrev_b32 v236, 4, v1
  v_xor_b32 v237, 64, v236
  s_mul_i32 s16, s54, 1056768
  s_lshl_b32 s17, s65, 6
  s_lshl_b32 s5, s5, 8
  s_xor_b32 s17, s17, s5
  s_add_u32 s16, s16, s17
  s_lshl_b32 s17, s66, 13
  s_add_u32 s16, s16, s17
  s_lshl_b32 s19, s54, 12
  s_lshl_b32 s13, s62, 15
  s_add_u32 s13, s13, 0xe00000
  v_bfe_u32 v1, v4, 2, 1
  v_bfe_u32 v2, v4, 3, 1
  v_lshl_add_u32 v1, v1, 1, v2
  v_lshl_add_u32 v1, v253, 2, v1
  v_mul_u32_u24 v249, 96, v1
  v_and_b32 v2, 3, v4
  v_lshl_add_u32 v249, v2, 3, v249
  v_add_u32 v249, s8, v249

  s_waitcnt lgkmcnt(0)
  s_barrier
  s_mov_b32 s60, 0
L_poll_2:
  buffer_load_dword v3, v238, s[36:39], s13 offen sc1
  s_add_u32 s60, s60, 1
  s_waitcnt vmcnt(0)
  v_cmp_ne_u32 vcc, s55, v3
  s_mov_b64 exec, vcc
  s_cbranch_execz L_pdone_3
  s_cmp_lt_u32 s60, 40000
  s_cbranch_scc1 L_poll_2
L_pdone_3:
  s_mov_b64 exec, -1
  s_add_u32 m0, s19, 35328
  s_add_u32 s14, s19, 0x500000
  buffer_load_dwordx4 v239, s[36:39], s16 offen offset:0 sc1 lds
  s_add_u32 s16, s16, 263168
  buffer_load_dwordx4 v239, s[36:39], s16 offen offset:1024 sc1 lds
  s_add_u32 s16, s16, 263168
  buffer_load_dwordx4 v239, s[36:39], s16 offen offset:2048 sc1 lds
  s_add_u32 s16, s16, 263168
  buffer_load_dwordx4 v239, s[36:39], s16 offen offset:3072 sc1 lds
  s_add_u32 m0, s19, 0
  s_nop 0
  buffer_load_dwordx4 v236, s[36:39], s14 offen sc1 lds
  buffer_load_dwordx4 v237, s[36:39], s14 offen offset:1024 sc1 lds
  buffer_load_dwordx4 v236, s[36:39], s14 offen offset:2048 sc1 lds
  buffer_load_dwordx4 v237, s[36:39], s14 offen offset:3072 sc1 lds
  ds_read_b64_tr_b16 a[0:1], v249 offset:0
  ds_read_b64_tr_b16 a[2:3], v249 offset:1536
  ds_read_b64_tr_b16 a[4:5], v249 offset:32
  ds_read_b64_tr_b16 a[6:7], v249 offset:1568
  ds_read_b64_tr_b16 a[8:9], v249 offset:64
  ds_read_b64_tr_b16 a[10:11], v249 offset:1600
  ds_read_b64_tr_b16 a[12:13], v249 offset:3072
  ds_read_b64_tr_b16 a[14:15], v249 offset:4608
  ds_read_b64_tr_b16 a[16:17], v249 offset:3104
  ds_read_b64_tr_b16 a[18:19], v249 offset:4640
  ds_read_b64_tr_b16 a[20:21], v249 offset:3136
  ds_read_b64_tr_b16 a[22:23], v249 offset:4672
  ds_read_b64_tr_b16 a[24:25], v249 offset:6144
  ds_read_b64_tr_b16 a[26:27], v249 offset:7680
  ds_read_b64_tr_b16 a[28:29], v249 offset:6176
  ds_read_b64_tr_b16 a[30:31], v249 offset:7712
  ds_read_b64_tr_b16 a[32:33], v249 offset:6208
  ds_read_b64_tr_b16 a[34:35], v249 offset:7744
  ds_read_b64_tr_b16 a[36:37], v249 offset:9216
  ds_read_b64_tr_b16 a[38:39], v249 offset:10752
  ds_read_b64_tr_b16 a[40:41], v249 offset:9248
  ds_read_b64_tr_b16 a[42:43], v249 offset:10784
  ds_read_b64_tr_b16 a[44:45], v249 offset:9280
  ds_read_b64_tr_b16 a[46:47], v249 offset:10816
  s_add_u32 s13, s12, 1048576
  s_waitcnt vmcnt(4)
  s_waitcnt lgkmcnt(0)
  s_barrier
  ds_read_b128 v[72:75], v240 offset:33280
  ds_read_b128 v[76:79], v240 offset:35328
  ds_read_b128 v[80:83], v240 offset:37376
  ds_read_b128 v[84:87], v240 offset:39424
  ds_read_b128 v[88:91], v240 offset:41472
  ds_read_b128 v[92:95], v240 offset:43520
  ds_read_b128 v[96:99], v240 offset:45568
  ds_read_b128 v[100:103], v240 offset:47616
  s_waitcnt lgkmcnt(7)
  v_mfma_f32_16x16x32_bf16 v[136:139], v[8:11], v[72:75], 0
  v_mfma_f32_16x16x32_bf16 v[140:143], v[12:15], v[72:75], 0
  s_add_u32 m0, s8, 12288
  s_mov_b32 s60, 352256
  v_mfma_f32_16x16x32_bf16 v[144:147], v[16:19], v[72:75], 0
  buffer_load_dwordx4 v250, s[40:43], s60 offen lds
  v_mfma_f32_16x16x32_bf16 v[148:151], v[20:23], v[72:75], 0
  v_mfma_f32_16x16x32_bf16 v[152:155], v[24:27], v[72:75], 0
  v_mfma_f32_16x16x32_bf16 v[156:159], v[28:31], v[72:75], 0
  v_mfma_f32_16x16x32_bf16 v[160:163], v[32:35], v[72:75], 0
  buffer_load_dwordx4 v251, s[40:43], s60 offen offset:1024 lds
  v_mfma_f32_16x16x32_bf16 v[164:167], v[36:39], v[72:75], 0
  s_waitcnt lgkmcnt(0)
  v_mfma_f32_16x16x32_bf16 v[140:143], v[8:11], v[76:79], v[140:143]
  v_mfma_f32_16x16x32_bf16 v[144:147], v[12:15], v[76:79], v[144:147]
  v_mfma_f32_16x16x32_bf16 v[148:151], v[16:19], v[76:79], v[148:151]
  ds_read_b128 v[104:107], v241 offset:33280
  buffer_load_dwordx4 v252, s[40:43], s60 offen offset:2048 lds
  v_mfma_f32_16x16x32_bf16 v[152:155], v[20:23], v[76:79], v[152:155]
  ds_read_b128 v[108:111], v241 offset:35328
  v_mfma_f32_16x16x32_bf16 v[156:159], v[24:27], v[76:79], v[156:159]
  ds_read_b128 v[112:115], v241 offset:37376
  v_mfma_f32_16x16x32_bf16 v[160:163], v[28:31], v[76:79], v[160:163]
  ds_read_b128 v[116:119], v241 offset:39424
  s_add_u32 m0, s8, 15360
  s_mov_b32 s60, 440320
  v_mfma_f32_16x16x32_bf16 v[164:167], v[32:35], v[76:79], v[164:167]
  ds_read_b128 v[120:123], v241 offset:41472
  buffer_load_dwordx4 v250, s[40:43], s60 offen lds
  v_mfma_f32_16x16x32_bf16 v[144:147], v[8:11], v[80:83], v[144:147]
  ds_read_b128 v[124:127], v241 offset:43520
  v_mfma_f32_16x16x32_bf16 v[148:151], v[12:15], v[80:83], v[148:151]
  ds_read_b128 v[128:131], v241 offset:45568
  v_mfma_f32_16x16x32_bf16 v[152:155], v[16:19], v[80:83], v[152:155]
  ds_read_b128 v[132:135], v241 offset:47616
  v_mfma_f32_16x16x32_bf16 v[156:159], v[20:23], v[80:83], v[156:159]
  buffer_load_dwordx4 v251, s[40:43], s60 offen offset:1024 lds
  v_mfma_f32_16x16x32_bf16 v[160:163], v[24:27], v[80:83], v[160:163]
  v_mfma_f32_16x16x32_bf16 v[164:167], v[28:31], v[80:83], v[164:167]
  v_mfma_f32_16x16x32_bf16 v[148:151], v[8:11], v[84:87], v[148:151]
  v_mfma_f32_16x16x32_bf16 v[152:155], v[12:15], v[84:87], v[152:155]
  buffer_load_dwordx4 v252, s[40:43], s60 offen offset:2048 lds
  v_mfma_f32_16x16x32_bf16 v[156:159], v[16:19], v[84:87], v[156:159]
  v_mfma_f32_16x16x32_bf16 v[160:163], v[20:23], v[84:87], v[160:163]
  v_mfma_f32_16x16x32_bf16 v[164:167], v[24:27], v[84:87], v[164:167]
  s_add_u32 m0, s8, 18432
  s_mov_b32 s60, 528384
  v_mfma_f32_16x16x32_bf16 v[152:155], v[8:11], v[88:91], v[152:155]
  buffer_load_dwordx4 v250, s[40:43], s60 offen lds
  v_mfma_f32_16x16x32_bf16 v[156:159], v[12:15], v[88:91], v[156:159]
  v_mfma_f32_16x16x32_bf16 v[160:163], v[16:19], v[88:91], v[160:163]
  v_mfma_f32_16x16x32_bf16 v[164:167], v[20:23], v[88:91], v[164:167]
  v_mfma_f32_16x16x32_bf16 v[156:159], v[8:11], v[92:95], v[156:159]
  buffer_load_dwordx4 v251, s[40:43], s60 offen offset:1024 lds
  v_mfma_f32_16x16x32_bf16 v[160:163], v[12:15], v[92:95], v[160:163]
  v_mfma_f32_16x16x32_bf16 v[164:167], v[16:19], v[92:95], v[164:167]
  v_mfma_f32_16x16x32_bf16 v[160:163], v[8:11], v[96:99], v[160:163]
  v_mfma_f32_16x16x32_bf16 v[164:167], v[12:15], v[96:99], v[164:167]
  buffer_load_dwordx4 v252, s[40:43], s60 offen offset:2048 lds
  v_mfma_f32_16x16x32_bf16 v[164:167], v[8:11], v[100:103], v[164:167]
  s_waitcnt lgkmcnt(0)
  v_mfma_f32_16x16x32_bf16 v[136:139], v[40:43], v[104:107], v[136:139]
  v_mfma_f32_16x16x32_bf16 v[140:143], v[44:47], v[104:107], v[140:143]
  s_add_u32 m0, s8, 21504
  s_mov_b32 s60, 616448
  v_mfma_f32_16x16x32_bf16 v[144:147], v[48:51], v[104:107], v[144:147]
  buffer_load_dwordx4 v250, s[40:43], s60 offen lds
  v_mfma_f32_16x16x32_bf16 v[148:151], v[52:55], v[104:107], v[148:151]
  v_mfma_f32_16x16x32_bf16 v[152:155], v[56:59], v[104:107], v[152:155]
  v_mfma_f32_16x16x32_bf16 v[156:159], v[60:63], v[104:107], v[156:159]
  v_mfma_f32_16x16x32_bf16 v[160:163], v[64:67], v[104:107], v[160:163]
  buffer_load_dwordx4 v251, s[40:43], s60 offen offset:1024 lds
  v_mfma_f32_16x16x32_bf16 v[164:167], v[68:71], v[104:107], v[164:167]
  v_mfma_f32_16x16x32_bf16 v[140:143], v[40:43], v[108:111], v[140:143]
  v_mfma_f32_16x16x32_bf16 v[144:147], v[44:47], v[108:111], v[144:147]
  v_mfma_f32_16x16x32_bf16 v[148:151], v[48:51], v[108:111], v[148:151]
  ds_read_b128 v[72:75], v242 offset:33280
  buffer_load_dwordx4 v252, s[40:43], s60 offen offset:2048 lds
  v_mfma_f32_16x16x32_bf16 v[152:155], v[52:55], v[108:111], v[152:155]
  ds_read_b128 v[76:79], v242 offset:35328
  v_mfma_f32_16x16x32_bf16 v[156:159], v[56:59], v[108:111], v[156:159]
  ds_read_b128 v[80:83], v242 offset:37376
  v_mfma_f32_16x16x32_bf16 v[160:163], v[60:63], v[108:111], v[160:163]
  ds_read_b128 v[84:87], v242 offset:39424
  s_add_u32 m0, s8, 0
  s_mov_b32 s60, 704512
  s_waitcnt vmcnt(12)
  s_barrier
  v_mfma_f32_16x16x32_bf16 v[164:167], v[64:67], v[108:111], v[164:167]
  ds_read_b128 v[88:91], v242 offset:41472
  buffer_load_dwordx4 v250, s[40:43], s60 offen lds
  v_mfma_f32_16x16x32_bf16 v[144:147], v[40:43], v[112:115], v[144:147]
  ds_read_b128 v[92:95], v242 offset:43520
  v_mfma_f32_16x16x32_bf16 v[148:151], v[44:47], v[112:115], v[148:151]
  ds_read_b128 v[96:99], v242 offset:45568
  v_mfma_f32_16x16x32_bf16 v[152:155], v[48:51], v[112:115], v[152:155]
  ds_read_b128 v[100:103], v242 offset:47616
  v_mfma_f32_16x16x32_bf16 v[156:159], v[52:55], v[112:115], v[156:159]
  buffer_load_dwordx4 v251, s[40:43], s60 offen offset:1024 lds
  ds_read_b64 v[16:17], v246 offset:35328
  v_mfma_f32_16x16x32_bf16 v[160:163], v[56:59], v[112:115], v[160:163]
  ds_read_b128 v[184:187], v245 offset:0
  v_mfma_f32_16x16x32_bf16 v[164:167], v[60:63], v[112:115], v[164:167]
  ds_read_b128 v[188:191], v204 offset:0
  v_mfma_f32_16x16x32_bf16 v[148:151], v[40:43], v[116:119], v[148:151]
  ds_read_b64 v[8:9], v201 offset:35328
  v_mfma_f32_16x16x32_bf16 v[152:155], v[44:47], v[116:119], v[152:155]
  buffer_load_dwordx4 v252, s[40:43], s60 offen offset:2048 lds
  ds_read_b64 v[18:19], v200 offset:39424
  v_mfma_f32_16x16x32_bf16 v[156:159], v[48:51], v[116:119], v[156:159]
  ds_read_b128 v[192:195], v205 offset:4096
  v_mfma_f32_16x16x32_bf16 v[160:163], v[52:55], v[116:119], v[160:163]
  ds_read_b128 v[196:199], v206 offset:4096
  v_mfma_f32_16x16x32_bf16 v[164:167], v[56:59], v[116:119], v[164:167]
  s_add_u32 m0, s8, 3072
  s_mov_b32 s60, 792576
  ds_read_b64 v[10:11], v202 offset:39424
  v_mfma_f32_16x16x32_bf16 v[152:155], v[40:43], v[120:123], v[152:155]
  buffer_load_dwordx4 v250, s[40:43], s60 offen lds
  ds_read_b64 v[20:21], v246 offset:43520
  v_mfma_f32_16x16x32_bf16 v[156:159], v[44:47], v[120:123], v[156:159]
  ds_read_b128 v[208:211], v245 offset:8192
  v_mfma_f32_16x16x32_bf16 v[160:163], v[48:51], v[120:123], v[160:163]
  ds_read_b128 v[212:215], v204 offset:8192
  v_mfma_f32_16x16x32_bf16 v[164:167], v[52:55], v[120:123], v[164:167]
  ds_read_b64 v[12:13], v201 offset:43520
  v_mfma_f32_16x16x32_bf16 v[156:159], v[40:43], v[124:127], v[156:159]
  buffer_load_dwordx4 v251, s[40:43], s60 offen offset:1024 lds
  ds_read_b64 v[22:23], v200 offset:47616
  v_mfma_f32_16x16x32_bf16 v[160:163], v[44:47], v[124:127], v[160:163]
  ds_read_b128 v[216:219], v205 offset:12288
  v_mfma_f32_16x16x32_bf16 v[164:167], v[48:51], v[124:127], v[164:167]
  ds_read_b128 v[220:223], v206 offset:12288
  v_mfma_f32_16x16x32_bf16 v[160:163], v[40:43], v[128:131], v[160:163]
  ds_read_b64 v[14:15], v202 offset:47616
  v_mfma_f32_16x16x32_bf16 v[164:167], v[44:47], v[128:131], v[164:167]
  buffer_load_dwordx4 v252, s[40:43], s60 offen offset:2048 lds
  v_mfma_f32_16x16x32_bf16 v[164:167], v[40:43], v[132:135], v[164:167]
  s_waitcnt lgkmcnt(15)
  v_mfma_f32_16x16x32_bf16 v[136:139], a[192:195], v[72:75], v[136:139]
  s_waitcnt lgkmcnt(0)
  v_mfma_f32_16x16x32_bf16 v[140:143], a[196:199], v[72:75], v[140:143]
  s_add_u32 m0, s8, 6144
  s_mov_b32 s60, 880640
  v_lshlrev_b32 v224, 16, v16
  v_mfma_f32_16x16x32_bf16 v[144:147], a[200:203], v[72:75], v[144:147]
  buffer_load_dwordx4 v250, s[40:43], s60 offen lds
  v_and_b32 v225, s9, v16
  v_mfma_f32_16x16x32_bf16 v[148:151], a[204:207], v[72:75], v[148:151]
  v_lshlrev_b32 v226, 16, v17
  v_mfma_f32_16x16x32_bf16 v[152:155], a[208:211], v[72:75], v[152:155]
  v_and_b32 v227, s9, v17
  v_mfma_f32_16x16x32_bf16 v[156:159], a[212:215], v[72:75], v[156:159]
  v_fma_f32 v24, v224, v184, v185
  v_mfma_f32_16x16x32_bf16 v[160:163], a[216:219], v[72:75], v[160:163]
  buffer_load_dwordx4 v251, s[40:43], s60 offen offset:1024 lds
  v_fma_f32 v25, v225, v186, v187
  v_mfma_f32_16x16x32_bf16 v[164:167], a[220:223], v[72:75], v[164:167]
  v_fma_f32 v26, v226, v188, v189
  v_mfma_f32_16x16x32_bf16 v[140:143], a[192:195], v[76:79], v[140:143]
  v_fma_f32 v27, v227, v190, v191
  v_mfma_f32_16x16x32_bf16 v[144:147], a[196:199], v[76:79], v[144:147]
  v_and_b32 v188, s9, v9
  v_mfma_f32_16x16x32_bf16 v[148:151], a[200:203], v[76:79], v[148:151]
  ds_read_b128 v[104:107], v243 offset:33280
  buffer_load_dwordx4 v252, s[40:43], s60 offen offset:2048 lds
  v_lshlrev_b32 v189, 16, v9
  v_mfma_f32_16x16x32_bf16 v[152:155], a[204:207], v[76:79], v[152:155]
  ds_read_b128 v[108:111], v243 offset:35328
  v_and_b32 v190, s9, v8
  v_mfma_f32_16x16x32_bf16 v[156:159], a[208:211], v[76:79], v[156:159]
  ds_read_b128 v[112:115], v243 offset:37376
  v_lshlrev_b32 v191, 16, v8
  v_mfma_f32_16x16x32_bf16 v[160:163], a[212:215], v[76:79], v[160:163]
  ds_read_b128 v[116:119], v243 offset:39424
  s_add_u32 m0, s8, 9216
  s_mov_b32 s60, 968704
  v_mul_f32 v188, s53, v188
  v_mfma_f32_16x16x32_bf16 v[164:167], a[216:219], v[76:79], v[164:167]
  ds_read_b128 v[120:123], v243 offset:41472
  buffer_load_dwordx4 v250, s[40:43], s60 offen lds
  v_mul_f32 v189, s53, v189
  v_mfma_f32_16x16x32_bf16 v[144:147], a[192:195], v[80:83], v[144:147]
  ds_read_b128 v[124:127], v243 offset:43520
  v_mul_f32 v190, s53, v190
  v_mfma_f32_16x16x32_bf16 v[148:151], a[196:199], v[80:83], v[148:151]
  ds_read_b128 v[128:131], v243 offset:45568
  v_mul_f32 v191, s53, v191
  v_mfma_f32_16x16x32_bf16 v[152:155], a[200:203], v[80:83], v[152:155]
  ds_read_b128 v[132:135], v243 offset:47616
  v_fma_f32 v184, v24, v188, v224
  v_mfma_f32_16x16x32_bf16 v[156:159], a[204:207], v[80:83], v[156:159]
  buffer_load_dwordx4 v251, s[40:43], s60 offen offset:1024 lds
  v_fma_f32 v185, v25, v189, v225
  v_mfma_f32_16x16x32_bf16 v[160:163], a[208:211], v[80:83], v[160:163]
  v_fma_f32 v186, v26, v190, v226
  v_mfma_f32_16x16x32_bf16 v[164:167], a[212:215], v[80:83], v[164:167]
  v_fma_f32 v187, v27, v191, v227
  v_mfma_f32_16x16x32_bf16 v[148:151], a[192:195], v[84:87], v[148:151]
  v_lshlrev_b32 v224, 16, v18
  v_mfma_f32_16x16x32_bf16 v[152:155], a[196:199], v[84:87], v[152:155]
  buffer_load_dwordx4 v252, s[40:43], s60 offen offset:2048 lds
  v_and_b32 v225, s9, v18
  v_mfma_f32_16x16x32_bf16 v[156:159], a[200:203], v[84:87], v[156:159]
  v_lshlrev_b32 v226, 16, v19
  v_mfma_f32_16x16x32_bf16 v[160:163], a[204:207], v[84:87], v[160:163]
  v_and_b32 v227, s9, v19
  v_mfma_f32_16x16x32_bf16 v[164:167], a[208:211], v[84:87], v[164:167]
  v_fma_f32 v28, v224, v192, v193
  v_mfma_f32_16x16x32_bf16 v[152:155], a[192:195], v[88:91], v[152:155]
  v_fma_f32 v29, v225, v194, v195
  v_mfma_f32_16x16x32_bf16 v[156:159], a[196:199], v[88:91], v[156:159]
  v_fma_f32 v30, v226, v196, v197
  v_mfma_f32_16x16x32_bf16 v[160:163], a[200:203], v[88:91], v[160:163]
  v_fma_f32 v31, v227, v198, v199
  v_mfma_f32_16x16x32_bf16 v[164:167], a[204:207], v[88:91], v[164:167]
  v_and_b32 v196, s9, v11
  v_mfma_f32_16x16x32_bf16 v[156:159], a[192:195], v[92:95], v[156:159]
  v_lshlrev_b32 v197, 16, v11
  v_mfma_f32_16x16x32_bf16 v[160:163], a[196:199], v[92:95], v[160:163]
  v_and_b32 v198, s9, v10
  v_mfma_f32_16x16x32_bf16 v[164:167], a[200:203], v[92:95], v[164:167]
  v_lshlrev_b32 v199, 16, v10
  v_mfma_f32_16x16x32_bf16 v[160:163], a[192:195], v[96:99], v[160:163]
  v_mul_f32 v196, s53, v196
  v_mfma_f32_16x16x32_bf16 v[164:167], a[196:199], v[96:99], v[164:167]
  v_mul_f32 v197, s53, v197
  v_mfma_f32_16x16x32_bf16 v[164:167], a[192:195], v[100:103], v[164:167]
  v_mul_f32 v198, s53, v198
  s_waitcnt lgkmcnt(0)
  s_cmp_lg_u32 s59, 0
  s_cbranch_scc1 L_rh1
  v_mfma_f32_16x16x32_bf16 v[140:143], a[224:227], v[108:111], v[140:143]
  v_mul_f32 v199, s53, v199
  v_fma_f32 v192, v28, v196, v224
  v_mfma_f32_16x16x32_bf16 v[140:143], a[228:231], v[104:107], v[140:143]
  v_fma_f32 v193, v29, v197, v225
  v_fma_f32 v194, v30, v198, v226
  v_mfma_f32_16x16x32_bf16 v[144:147], a[224:227], v[112:115], v[144:147]
  v_fma_f32 v195, v31, v199, v227
  v_lshlrev_b32 v224, 16, v20
  v_mfma_f32_16x16x32_bf16 v[144:147], a[228:231], v[108:111], v[144:147]
  v_and_b32 v225, s9, v20
  v_lshlrev_b32 v226, 16, v21
  v_mfma_f32_16x16x32_bf16 v[144:147], a[232:235], v[104:107], v[144:147]
  v_and_b32 v227, s9, v21
  v_fma_f32 v32, v224, v208, v209
  v_mfma_f32_16x16x32_bf16 v[156:159], a[224:227], v[124:127], v[156:159]
  v_fma_f32 v33, v225, v210, v211
  v_fma_f32 v34, v226, v212, v213
  v_mfma_f32_16x16x32_bf16 v[156:159], a[228:231], v[120:123], v[156:159]
  v_fma_f32 v35, v227, v214, v215
  v_and_b32 v212, s9, v13
  v_mfma_f32_16x16x32_bf16 v[156:159], a[232:235], v[116:119], v[156:159]
  v_lshlrev_b32 v213, 16, v13
  v_and_b32 v214, s9, v12
  v_mfma_f32_16x16x32_bf16 v[156:159], a[236:239], v[112:115], v[156:159]
  v_lshlrev_b32 v215, 16, v12
  v_mul_f32 v212, s53, v212
  v_mfma_f32_16x16x32_bf16 v[156:159], a[240:243], v[108:111], v[156:159]
  ds_write_b128 v247, v[140:143] offset:16384
  v_mul_f32 v213, s53, v213
  v_mul_f32 v214, s53, v214
  v_mfma_f32_16x16x32_bf16 v[156:159], a[244:247], v[104:107], v[156:159]
  v_mul_f32 v215, s53, v215
  v_fma_f32 v208, v32, v212, v224
  v_mfma_f32_16x16x32_bf16 v[160:163], a[224:227], v[128:131], v[160:163]
  v_fma_f32 v209, v33, v213, v225
  v_fma_f32 v210, v34, v214, v226
  v_mfma_f32_16x16x32_bf16 v[160:163], a[228:231], v[124:127], v[160:163]
  ds_write_b128 v247, v[144:147] offset:17408
  v_fma_f32 v211, v35, v215, v227
  v_lshlrev_b32 v224, 16, v22
  v_mfma_f32_16x16x32_bf16 v[160:163], a[232:235], v[120:123], v[160:163]
  v_and_b32 v225, s9, v22
  v_lshlrev_b32 v226, 16, v23
  v_mfma_f32_16x16x32_bf16 v[160:163], a[236:239], v[116:119], v[160:163]
  v_and_b32 v227, s9, v23
  v_fma_f32 v36, v224, v216, v217
  v_mfma_f32_16x16x32_bf16 v[160:163], a[240:243], v[112:115], v[160:163]
  v_fma_f32 v37, v225, v218, v219
  v_fma_f32 v38, v226, v220, v221
  v_mfma_f32_16x16x32_bf16 v[160:163], a[244:247], v[108:111], v[160:163]
  v_fma_f32 v39, v227, v222, v223
  v_and_b32 v220, s9, v15
  v_mfma_f32_16x16x32_bf16 v[160:163], a[248:251], v[104:107], v[160:163]
  v_lshlrev_b32 v221, 16, v15
  v_and_b32 v222, s9, v14
  v_mfma_f32_16x16x32_bf16 v[164:167], a[224:227], v[132:135], v[164:167]
  ds_write_b128 v247, v[156:159] offset:18432
  v_lshlrev_b32 v223, 16, v14
  v_mul_f32 v220, s53, v220
  v_mfma_f32_16x16x32_bf16 v[164:167], a[228:231], v[128:131], v[164:167]
  v_mul_f32 v221, s53, v221
  v_mul_f32 v222, s53, v222
  v_mfma_f32_16x16x32_bf16 v[164:167], a[232:235], v[124:127], v[164:167]
  v_mul_f32 v223, s53, v223
  v_fma_f32 v216, v36, v220, v224
  v_mfma_f32_16x16x32_bf16 v[164:167], a[236:239], v[120:123], v[164:167]
  v_fma_f32 v217, v37, v221, v225
  v_fma_f32 v218, v38, v222, v226
  v_mfma_f32_16x16x32_bf16 v[164:167], a[240:243], v[116:119], v[164:167]
  v_fma_f32 v219, v39, v223, v227
  v_mfma_f32_16x16x32_bf16 v[164:167], a[244:247], v[112:115], v[164:167]
  v_mfma_f32_16x16x32_bf16 v[164:167], a[248:251], v[108:111], v[164:167]
  v_mfma_f32_16x16x32_bf16 v[164:167], a[252:255], v[104:107], v[164:167]
  ds_write_b128 v247, v[160:163] offset:19456
  v_mfma_f32_16x16x32_bf16 v[152:155], a[224:227], v[120:123], v[152:155]
  v_mfma_f32_16x16x32_bf16 v[152:155], a[228:231], v[116:119], v[152:155]
  s_waitcnt lgkmcnt(0)
  s_barrier
  ds_read_b128 v[168:171], v203 offset:16384
  ds_read_b128 v[172:175], v203 offset:17408
  ds_read_b128 v[176:179], v203 offset:18432
  ds_read_b128 v[180:183], v203 offset:19456
  v_mfma_f32_16x16x32_bf16 v[152:155], a[232:235], v[112:115], v[152:155]
  v_mfma_f32_16x16x32_bf16 v[152:155], a[236:239], v[108:111], v[152:155]
  v_mfma_f32_16x16x32_bf16 v[152:155], a[240:243], v[104:107], v[152:155]
  v_mfma_f32_16x16x32_bf16 v[148:151], a[224:227], v[116:119], v[148:151]
  s_waitcnt lgkmcnt(0)
  v_fmac_f32 v184, v24, v168
  v_fmac_f32 v185, v25, v169
  v_fmac_f32 v186, v26, v170
  v_fmac_f32 v187, v27, v171
  v_mfma_f32_16x16x32_bf16 v[148:151], a[228:231], v[112:115], v[148:151]
  v_fmac_f32 v192, v28, v172
  v_fmac_f32 v193, v29, v173
  v_fmac_f32 v194, v30, v174
  v_fmac_f32 v195, v31, v175
  v_mfma_f32_16x16x32_bf16 v[148:151], a[232:235], v[108:111], v[148:151]
  v_fmac_f32 v208, v32, v176
  v_fmac_f32 v209, v33, v177
  v_fmac_f32 v210, v34, v178
  v_fmac_f32 v211, v35, v179
  v_mfma_f32_16x16x32_bf16 v[148:151], a[236:239], v[104:107], v[148:151]
  v_fmac_f32 v216, v36, v180
  v_fmac_f32 v217, v37, v181
  v_fmac_f32 v218, v38, v182
  v_fmac_f32 v219, v39, v183
  v_mfma_f32_16x16x32_bf16 v[136:139], a[224:227], v[104:107], v[136:139]
  s_nop 3
  v_pk_fma_f32 v[216:217], v[36:37], v[164:165], v[216:217]
  v_pk_fma_f32 v[218:219], v[38:39], v[166:167], v[218:219]
  v_pk_fma_f32 v[208:209], v[32:33], v[152:153], v[208:209]
  v_pk_fma_f32 v[210:211], v[34:35], v[154:155], v[210:211]
  v_pk_fma_f32 v[192:193], v[28:29], v[148:149], v[192:193]
  v_pk_fma_f32 v[194:195], v[30:31], v[150:151], v[194:195]
  s_nop 2
  v_pk_fma_f32 v[184:185], v[24:25], v[136:137], v[184:185]
  v_pk_fma_f32 v[186:187], v[26:27], v[138:139], v[186:187]
  s_branch L_cfin
L_rh1_w:
  s_setpc_b64 s[0:1]
L_rh1:
  v_mfma_f32_16x16x32_bf16 v[136:139], a[224:227], v[104:107], v[136:139]
  v_mul_f32 v199, s53, v199
  v_fma_f32 v192, v28, v196, v224
  v_mfma_f32_16x16x32_bf16 v[148:151], a[224:227], v[116:119], v[148:151]
  v_fma_f32 v193, v29, v197, v225
  v_fma_f32 v194, v30, v198, v226
  v_mfma_f32_16x16x32_bf16 v[148:151], a[228:231], v[112:115], v[148:151]
  v_fma_f32 v195, v31, v199, v227
  v_lshlrev_b32 v224, 16, v20
  v_mfma_f32_16x16x32_bf16 v[148:151], a[232:235], v[108:111], v[148:151]
  v_and_b32 v225, s9, v20
  v_lshlrev_b32 v226, 16, v21
  v_mfma_f32_16x16x32_bf16 v[148:151], a[236:239], v[104:107], v[148:151]
  v_and_b32 v227, s9, v21
  v_fma_f32 v32, v224, v208, v209
  v_mfma_f32_16x16x32_bf16 v[152:155], a[224:227], v[120:123], v[152:155]
  v_fma_f32 v33, v225, v210, v211
  v_fma_f32 v34, v226, v212, v213
  v_mfma_f32_16x16x32_bf16 v[152:155], a[228:231], v[116:119], v[152:155]
  v_fma_f32 v35, v227, v214, v215
  v_and_b32 v212, s9, v13
  v_mfma_f32_16x16x32_bf16 v[152:155], a[232:235], v[112:115], v[152:155]
  v_lshlrev_b32 v213, 16, v13
  v_and_b32 v214, s9, v12
  v_mfma_f32_16x16x32_bf16 v[152:155], a[236:239], v[108:111], v[152:155]
  ds_write_b128 v247, v[136:139] offset:16384
  v_lshlrev_b32 v215, 16, v12
  v_mul_f32 v212, s53, v212
  v_mfma_f32_16x16x32_bf16 v[152:155], a[240:243], v[104:107], v[152:155]
  v_mul_f32 v213, s53, v213
  v_mul_f32 v214, s53, v214
  v_mfma_f32_16x16x32_bf16 v[164:167], a[224:227], v[132:135], v[164:167]
  v_mul_f32 v215, s53, v215
  v_fma_f32 v208, v32, v212, v224
  v_mfma_f32_16x16x32_bf16 v[164:167], a[228:231], v[128:131], v[164:167]
  v_fma_f32 v209, v33, v213, v225
  v_fma_f32 v210, v34, v214, v226
  v_mfma_f32_16x16x32_bf16 v[164:167], a[232:235], v[124:127], v[164:167]
  ds_write_b128 v247, v[148:151] offset:17408
  v_fma_f32 v211, v35, v215, v227
  v_lshlrev_b32 v224, 16, v22
  v_mfma_f32_16x16x32_bf16 v[164:167], a[236:239], v[120:123], v[164:167]
  v_and_b32 v225, s9, v22
  v_lshlrev_b32 v226, 16, v23
  v_mfma_f32_16x16x32_bf16 v[164:167], a[240:243], v[116:119], v[164:167]
  v_and_b32 v227, s9, v23
  v_fma_f32 v36, v224, v216, v217
  v_mfma_f32_16x16x32_bf16 v[164:167], a[244:247], v[112:115], v[164:167]
  v_fma_f32 v37, v225, v218, v219
  v_fma_f32 v38, v226, v220, v221
  v_mfma_f32_16x16x32_bf16 v[164:167], a[248:251], v[108:111], v[164:167]
  v_fma_f32 v39, v227, v222, v223
  v_and_b32 v220, s9, v15
  v_mfma_f32_16x16x32_bf16 v[164:167], a[252:255], v[104:107], v[164:167]
  ds_write_b128 v247, v[152:155] offset:18432
  v_lshlrev_b32 v221, 16, v15
  v_and_b32 v222, s9, v14
  v_mfma_f32_16x16x32_bf16 v[160:163], a[224:227], v[128:131], v[160:163]
  v_lshlrev_b32 v223, 16, v14
  v_mul_f32 v220, s53, v220
  v_mfma_f32_16x16x32_bf16 v[160:163], a[228:231], v[124:127], v[160:163]
  v_mul_f32 v221, s53, v221
  v_mul_f32 v222, s53, v222
  v_mfma_f32_16x16x32_bf16 v[160:163], a[232:235], v[120:123], v[160:163]
  v_mul_f32 v223, s53, v223
  v_fma_f32 v216, v36, v220, v224
  v_mfma_f32_16x16x32_bf16 v[160:163], a[236:239], v[116:119], v[160:163]
  v_fma_f32 v217, v37, v221, v225
  v_fma_f32 v218, v38, v222, v226
  v_mfma_f32_16x16x32_bf16 v[160:163], a[240:243], v[112:115], v[160:163]
  v_fma_f32 v219, v39, v223, v227
  v_mfma_f32_16x16x32_bf16 v[160:163], a[244:247], v[108:111], v[160:163]
  v_mfma_f32_16x16x32_bf16 v[160:163], a[248:251], v[104:107], v[160:163]
  v_mfma_f32_16x16x32_bf16 v[156:159], a[224:227], v[124:127], v[156:159]
  ds_write_b128 v247, v[164:167] offset:19456
  v_mfma_f32_16x16x32_bf16 v[156:159], a[228:231], v[120:123], v[156:159]
  v_mfma_f32_16x16x32_bf16 v[156:159], a[232:235], v[116:119], v[156:159]
  s_waitcnt lgkmcnt(0)
  s_barrier
  ds_read_b128 v[168:171], v203 offset:16384
  ds_read_b128 v[172:175], v203 offset:17408
  ds_read_b128 v[176:179], v203 offset:18432
  ds_read_b128 v[180:183], v203 offset:19456
  v_mfma_f32_16x16x32_bf16 v[156:159], a[236:239], v[112:115], v[156:159]
  v_mfma_f32_16x16x32_bf16 v[156:159], a[240:243], v[108:111], v[156:159]
  v_mfma_f32_16x16x32_bf16 v[156:159], a[244:247], v[104:107], v[156:159]
  v_mfma_f32_16x16x32_bf16 v[144:147], a[224:227], v[112:115], v[144:147]
  s_waitcnt lgkmcnt(0)
  v_fmac_f32 v184, v24, v168
  v_fmac_f32 v185, v25, v169
  v_fmac_f32 v186, v26, v170
  v_fmac_f32 v187, v27, v171
  v_mfma_f32_16x16x32_bf16 v[144:147], a[228:231], v[108:111], v[144:147]
  v_fmac_f32 v192, v28, v172
  v_fmac_f32 v193, v29, v173
  v_fmac_f32 v194, v30, v174
  v_fmac_f32 v195, v31, v175
  v_mfma_f32_16x16x32_bf16 v[144:147], a[232:235], v[104:107], v[144:147]
  v_fmac_f32 v208, v32, v176
  v_fmac_f32 v209, v33, v177
  v_fmac_f32 v210, v34, v178
  v_fmac_f32 v211, v35, v179
  v_mfma_f32_16x16x32_bf16 v[140:143], a[224:227], v[108:111], v[140:143]
  v_fmac_f32 v216, v36, v180
  v_fmac_f32 v217, v37, v181
  v_fmac_f32 v218, v38, v182
  v_fmac_f32 v219, v39, v183
  v_mfma_f32_16x16x32_bf16 v[140:143], a[228:231], v[104:107], v[140:143]
  s_nop 3
  v_pk_fma_f32 v[216:217], v[36:37], v[160:161], v[216:217]
  v_pk_fma_f32 v[218:219], v[38:39], v[162:163], v[218:219]
  v_pk_fma_f32 v[208:209], v[32:33], v[156:157], v[208:209]
  v_pk_fma_f32 v[210:211], v[34:35], v[158:159], v[210:211]
  v_pk_fma_f32 v[192:193], v[28:29], v[144:145], v[192:193]
  v_pk_fma_f32 v[194:195], v[30:31], v[146:147], v[194:195]
  s_nop 2
  v_pk_fma_f32 v[184:185], v[24:25], v[140:141], v[184:185]
  v_pk_fma_f32 v[186:187], v[26:27], v[142:143], v[186:187]
  s_branch L_cfin
L_cfin_w:
  s_setpc_b64 s[0:1]
L_cfin:
  v_cvt_pk_bf16_f32 v224, v184, v185
  v_cvt_pk_bf16_f32 v225, v186, v187
  v_cvt_pk_bf16_f32 v226, v192, v193
  v_cvt_pk_bf16_f32 v227, v194, v195
  v_cvt_pk_bf16_f32 v228, v208, v209
  v_cvt_pk_bf16_f32 v229, v210, v211
  v_cvt_pk_bf16_f32 v230, v216, v217
  v_cvt_pk_bf16_f32 v231, v218, v219
  s_nop 0
  v_permlane16_swap_b32 v224, v226
  v_permlane16_swap_b32 v225, v227
  v_permlane16_swap_b32 v228, v230
  v_permlane16_swap_b32 v229, v231
  buffer_store_dwordx4 v[224:227], v244, s[36:39], s12 offen sc1
  buffer_store_dwordx4 v[228:231], v244, s[36:39], s13 offen sc1
  s_waitcnt vmcnt(2)
  ds_read_b64_tr_b16 a[48:49], v249 offset:12288
  ds_read_b64_tr_b16 a[50:51], v249 offset:13824
  ds_read_b64_tr_b16 a[52:53], v249 offset:12320
  ds_read_b64_tr_b16 a[54:55], v249 offset:13856
  ds_read_b64_tr_b16 a[56:57], v249 offset:12352
  ds_read_b64_tr_b16 a[58:59], v249 offset:13888
  ds_read_b64_tr_b16 a[60:61], v249 offset:15360
  ds_read_b64_tr_b16 a[62:63], v249 offset:16896
  ds_read_b64_tr_b16 a[64:65], v249 offset:15392
  ds_read_b64_tr_b16 a[66:67], v249 offset:16928
  ds_read_b64_tr_b16 a[68:69], v249 offset:15424
  ds_read_b64_tr_b16 a[70:71], v249 offset:16960
  ds_read_b64_tr_b16 a[72:73], v249 offset:18432
  ds_read_b64_tr_b16 a[74:75], v249 offset:19968
  ds_read_b64_tr_b16 a[76:77], v249 offset:18464
  ds_read_b64_tr_b16 a[78:79], v249 offset:20000
  ds_read_b64_tr_b16 a[80:81], v249 offset:18496
  ds_read_b64_tr_b16 a[82:83], v249 offset:20032
  ds_read_b64_tr_b16 a[84:85], v249 offset:21504
  ds_read_b64_tr_b16 a[86:87], v249 offset:23040
  ds_read_b64_tr_b16 a[88:89], v249 offset:21536
  ds_read_b64_tr_b16 a[90:91], v249 offset:23072
  ds_read_b64_tr_b16 a[92:93], v249 offset:21568
  ds_read_b64_tr_b16 a[94:95], v249 offset:23104
  ds_read_b64_tr_b16 a[96:97], v249 offset:0
  ds_read_b64_tr_b16 a[98:99], v249 offset:1536
  ds_read_b64_tr_b16 a[100:101], v249 offset:32
  ds_read_b64_tr_b16 a[102:103], v249 offset:1568
  ds_read_b64_tr_b16 a[104:105], v249 offset:64
  ds_read_b64_tr_b16 a[106:107], v249 offset:1600
  ds_read_b64_tr_b16 a[108:109], v249 offset:3072
  ds_read_b64_tr_b16 a[110:111], v249 offset:4608
  ds_read_b64_tr_b16 a[112:113], v249 offset:3104
  ds_read_b64_tr_b16 a[114:115], v249 offset:4640
  ds_read_b64_tr_b16 a[116:117], v249 offset:3136
  ds_read_b64_tr_b16 a[118:119], v249 offset:4672
  ds_read_b64_tr_b16 a[120:121], v249 offset:6144
  ds_read_b64_tr_b16 a[122:123], v249 offset:7680
  ds_read_b64_tr_b16 a[124:125], v249 offset:6176
  ds_read_b64_tr_b16 a[126:127], v249 offset:7712
  ds_read_b64_tr_b16 a[128:129], v249 offset:6208
  ds_read_b64_tr_b16 a[130:131], v249 offset:7744
  ds_read_b64_tr_b16 a[132:133], v249 offset:9216
  ds_read_b64_tr_b16 a[134:135], v249 offset:10752
  ds_read_b64_tr_b16 a[136:137], v249 offset:9248
  ds_read_b64_tr_b16 a[138:139], v249 offset:10784
  ds_read_b64_tr_b16 a[140:141], v249 offset:9280
  ds_read_b64_tr_b16 a[142:143], v249 offset:10816
  s_lshl_b32 s61, s67, 6
  s_add_u32 s61, s61, 0xe40000
  v_mov_b32 v3, s55
  v_lshlrev_b32 v2, 15, v4

  s_waitcnt vmcnt(0)
  s_cmp_lg_u32 s54, 0
  s_barrier
  s_cbranch_scc1 L_nofl_4
  s_mov_b64 exec, 255
  buffer_store_dword v3, v2, s[36:39], s61 offen sc1

  s_cmp_lg_u32 s2, 0
  s_cbranch_scc1 L_noep_5
  s_mov_b64 exec, 1
  s_mov_b32 s60, 0xe90000
  buffer_store_dword v3, v2, s[36:39], s60 offen sc1
L_noep_5:
  s_mov_b64 exec, -1
L_nofl_4:
  s_waitcnt lgkmcnt(0)
  s_add_u32 m0, s8, 12288
  s_mov_b32 s60, 1056768
  buffer_load_dwordx4 v250, s[40:43], s60 offen lds
  buffer_load_dwordx4 v251, s[40:43], s60 offen offset:1024 lds
  buffer_load_dwordx4 v252, s[40:43], s60 offen offset:2048 lds
  s_add_u32 m0, s8, 15360
  s_mov_b32 s60, 1144832
  buffer_load_dwordx4 v250, s[40:43], s60 offen lds
  buffer_load_dwordx4 v251, s[40:43], s60 offen offset:1024 lds
  buffer_load_dwordx4 v252, s[40:43], s60 offen offset:2048 lds
  s_add_u32 m0, s8, 18432
  s_mov_b32 s60, 1232896
  buffer_load_dwordx4 v250, s[40:43], s60 offen lds
  buffer_load_dwordx4 v251, s[40:43], s60 offen offset:1024 lds
  buffer_load_dwordx4 v252, s[40:43], s60 offen offset:2048 lds
  s_add_u32 m0, s8, 21504
  s_mov_b32 s60, 1320960
  buffer_load_dwordx4 v250, s[40:43], s60 offen lds
  buffer_load_dwordx4 v251, s[40:43], s60 offen offset:1024 lds
  buffer_load_dwordx4 v252, s[40:43], s60 offen offset:2048 lds
  v_mov_b32 v116, 0x3f803f80
  v_mov_b32 v117, 0x3f803f80
  v_mov_b32 v118, 0x3f803f80
  v_mov_b32 v119, 0x3f803f80
  s_nop 1
  v_mfma_f32_16x16x32_bf16 v[104:107], a[0:3], v[116:119], 0
  v_bfe_u32 v6, v4, 1, 2
  v_xor_b32 v6, v6, v253
  v_lshlrev_b32 v6, 5, v6
  v_and_b32 v7, 1, v4
  v_mfma_f32_16x16x32_bf16 v[108:111], a[4:7], v[116:119], 0
  v_lshl_add_u32 v6, v7, 4, v6
  v_lshrrev_b32 v7, 3, v4
  v_lshl_add_u32 v205, v7, 10, v6
  v_add_u32 v206, 7168, v205
  v_mfma_f32_16x16x32_bf16 v[112:115], a[8:11], v[116:119], 0
  v_lshrrev_b32 v6, 2, v4
  v_lshlrev_b32 v7, 7, v6
  v_and_b32 v1, 3, v4
  v_lshl_add_u32 v7, v1, 3, v7
  v_mfma_f32_16x16x32_bf16 v[104:107], a[12:15], v[116:119], v[104:107]
  v_bfe_u32 v6, v4, 3, 2
  v_xor_b32 v6, s54, v6
  v_lshl_add_u32 v5, v6, 5, v7
  v_add_u32 v212, s8, v5
  v_mfma_f32_16x16x32_bf16 v[108:111], a[16:19], v[116:119], v[108:111]
  s_lshl_b32 s27, s54, 13
  v_add_u32 v216, s27, v5
  s_cmp_eq_u32 s54, 3
  s_cselect_b32 s5, 0, 4096
  v_mfma_f32_16x16x32_bf16 v[112:115], a[20:23], v[116:119], v[112:115]
  s_add_u32 s5, s5, 16384
  v_add_u32 v220, s5, v212
  v_and_b32 v6, 1, v253
  v_lshlrev_b32 v6, 5, v6
  v_mfma_f32_16x16x32_bf16 v[104:107], a[24:27], v[116:119], v[104:107]
  v_xor_b32 v204, v6, v255
  v_lshl_add_u32 v6, v1, 3, v6
  v_lshrrev_b32 v7, 2, v4
  v_lshl_add_u32 v200, v7, 6, v6
  v_mfma_f32_16x16x32_bf16 v[108:111], a[28:31], v[116:119], v[108:111]
  v_xor_b32 v201, 32, v200
  s_lshl_b32 s5, s59, 5
  v_xor_b32 v202, s5, v200
  s_lshl_b32 s5, s58, 14
  v_mfma_f32_16x16x32_bf16 v[112:115], a[32:35], v[116:119], v[112:115]
  v_add_u32 v202, s5, v202
  v_bfe_u32 v7, v4, 2, 1
  v_lshl_add_u32 v6, v7, 7, v6
  v_bfe_u32 v7, v4, 3, 1
  v_mfma_f32_16x16x32_bf16 v[104:107], a[36:39], v[116:119], v[104:107]
  v_lshl_add_u32 v6, v7, 6, v6
  v_lshl_add_u32 v203, v253, 8, v6
  s_lshl_b32 s4, s69, 12
  s_lshl_b32 s5, s54, 10
  v_mfma_f32_16x16x32_bf16 v[108:111], a[40:43], v[116:119], v[108:111]
  s_add_u32 s4, s4, s5
  v_add_u32 v203, s4, v203
  v_cmp_eq_u32 s[16:17], 1, v1
  v_cmp_eq_u32 s[18:19], 2, v1
  v_mfma_f32_16x16x32_bf16 v[112:115], a[44:47], v[116:119], v[112:115]
  v_cmp_eq_u32 s[20:21], 3, v1
  s_mov_b32 s22, 0x00f0000f
  s_mov_b32 s23, 0xf0000f00
  v_lshrrev_b32 v6, 3, v4
  v_mfma_f32_16x16x32_bf16 v[104:107], a[48:51], v[116:119], v[104:107]
  v_lshlrev_b32 v6, 5, v6
  v_and_b32 v1, 7, v4
  v_add_u32 v6, v6, v1
  s_lshl_b32 s5, s54, 3
  v_mfma_f32_16x16x32_bf16 v[108:111], a[52:55], v[116:119], v[108:111]
  v_add_u32 v6, s5, v6
  v_lshlrev_b32 v1, 6, v6
  s_lshl_b32 s24, s68, 16
  s_lshl_b32 s25, s54, 10
  v_mfma_f32_16x16x32_bf16 v[112:115], a[56:59], v[116:119], v[112:115]
  s_add_u32 s24, s24, s25
  s_add_u32 s24, s24, 0x520000
  s_mul_i32 s26, s54, 360448
  s_lshl_b32 s5, s69, 7
  v_mfma_f32_16x16x32_bf16 v[104:107], a[60:63], v[116:119], v[104:107]
  s_add_u32 s26, s26, s5
  v_lshlrev_b32 v207, 4, v254
  v_add_u32 v207, 159744, v207
  s_mul_i32 s28, s68, 180224
  v_mfma_f32_16x16x32_bf16 v[108:111], a[64:67], v[116:119], v[108:111]
  s_add_u32 s28, s28, 0x7c0000
  s_lshr_b32 s5, s69, 1
  s_mul_i32 s5, s5, 45056
  s_add_u32 s4, s28, s5
  v_mfma_f32_16x16x32_bf16 v[112:115], a[68:71], v[116:119], v[112:115]
  s_and_b32 s5, s69, 1
  s_lshl_b32 s29, s5, 14
  s_lshl_b32 s11, s54, 12
  s_add_u32 s29, s29, s11
  v_mfma_f32_16x16x32_bf16 v[104:107], a[72:75], v[116:119], v[104:107]
  s_add_u32 s29, s29, s4
  s_lshl_b32 s30, s5, 12
  s_lshl_b32 s11, s54, 11
  s_add_u32 s30, s30, s11
  v_mfma_f32_16x16x32_bf16 v[108:111], a[76:79], v[116:119], v[108:111]
  s_add_u32 s30, s30, 32768
  s_lshl_b32 s11, s5, 11
  s_add_u32 s11, s11, 40960
  s_cmp_eq_u32 s54, 2
  v_mfma_f32_16x16x32_bf16 v[112:115], a[80:83], v[116:119], v[112:115]
  s_cselect_b32 s30, s11, s30
  s_add_u32 s30, s30, s4
  s_cmp_eq_u32 s54, 3
  s_cselect_b32 s11, 0x7fff0000, 0
  v_mfma_f32_16x16x32_bf16 v[104:107], a[84:87], v[116:119], v[104:107]
  v_add_u32 v208, s11, v255
  s_mul_i32 s5, s54, 45056
  s_add_u32 s28, s28, s5
  s_lshl_b32 s13, s62, 15
  v_mfma_f32_16x16x32_bf16 v[108:111], a[88:91], v[116:119], v[108:111]
  s_add_u32 s13, s13, 0xe40000
  s_lshl_b32 s4, s68, 3
  s_lshl_b32 s5, s54, 1
  s_add_u32 s4, s4, s5
  v_mfma_f32_16x16x32_bf16 v[112:115], a[92:95], v[116:119], v[112:115]
  v_add_u32 v232, s4, v4
  v_lshlrev_b32 v232, 7, v232
  s_mov_b32 s14, 0xe80000
  s_mov_b32 s15, 0xe88000
  v_mfma_f32_16x16x32_bf16 v[104:107], a[96:99], v[116:119], v[104:107]
  s_add_u32 s5, s27, 32768
  v_add_u32 v228, s5, v255
  v_xor_b32 v225, 0x2000, v228
  v_xor_b32 v226, 0x4000, v228
  v_mfma_f32_16x16x32_bf16 v[108:111], a[100:103], v[116:119], v[108:111]
  v_xor_b32 v227, 0x6000, v228
  v_and_b32 v224, 1, v253
  v_lshl_add_u32 v224, v224, 4, v254
  v_lshlrev_b32 v224, 10, v224
  v_mfma_f32_16x16x32_bf16 v[112:115], a[104:107], v[116:119], v[112:115]
  v_and_b32 v6, 2, v253
  v_lshl_add_u32 v224, v6, 3, v224
  s_lshl_b32 s12, s68, 16
  s_lshl_b32 s5, s69, 7
  v_mfma_f32_16x16x32_bf16 v[104:107], a[108:111], v[116:119], v[104:107]
  s_add_u32 s12, s12, s5
  s_lshl_b32 s5, s54, 5
  s_add_u32 s12, s12, s5
  s_add_u32 s31, s12, 32768
  v_mfma_f32_16x16x32_bf16 v[108:111], a[112:115], v[116:119], v[108:111]
  v_lshl_add_u32 v6, v4, 3, s69
  v_lshrrev_b32 v7, 4, v6
  v_and_b32 v6, 15, v6
  v_lshlrev_b32 v229, 12, v7
  v_mfma_f32_16x16x32_bf16 v[112:115], a[116:119], v[116:119], v[112:115]
  v_lshl_add_u32 v229, v6, 7, v229
  v_cmp_lt_u32 vcc, 7, v7
  v_and_b32 v6, 8, v6
  v_lshlrev_b32 v6, 7, v6
  v_mfma_f32_16x16x32_bf16 v[104:107], a[120:123], v[116:119], v[104:107]
  v_cndmask_b32 v6, 0, v6, vcc
  v_add_u32 v229, v229, v6
  v_mov_b32 v6, 0x800
  v_mov_b32 v7, 0x400
  v_mfma_f32_16x16x32_bf16 v[108:111], a[124:127], v[116:119], v[108:111]
  v_cndmask_b32 v6, v6, v7, vcc
  v_add_u32 v230, v229, v6
  v_lshlrev_b32 v231, 12, v4
  s_lshl_b32 s5, s69, 7
  v_mfma_f32_16x16x32_bf16 v[112:115], a[128:131], v[116:119], v[112:115]
  v_add_u32 v231, s5, v231
  v_xor_b32 v213, 32, v212
  v_xor_b32 v214, 64, v212
  v_xor_b32 v215, 96, v212
  v_mfma_f32_16x16x32_bf16 v[104:107], a[132:135], v[116:119], v[104:107]
  v_xor_b32 v217, 32, v216
  v_xor_b32 v218, 64, v216
  v_xor_b32 v219, 96, v216
  v_xor_b32 v221, 32, v220
  v_mfma_f32_16x16x32_bf16 v[108:111], a[136:139], v[116:119], v[108:111]
  v_xor_b32 v222, 64, v220
  v_xor_b32 v223, 96, v220
  v_mfma_f32_16x16x32_bf16 v[112:115], a[140:143], v[116:119], v[112:115]
  s_mov_b32 s60, 0
L_poll_6:
  buffer_load_dword v3, v1, s[36:39], s13 offen sc1
  s_add_u32 s60, s60, 1
  s_waitcnt vmcnt(0)
  v_cmp_ne_u32 vcc, s55, v3
  s_mov_b64 exec, vcc
  s_cbranch_execz L_pdone_7
  s_cmp_lt_u32 s60, 40000
  s_cbranch_scc1 L_poll_6
L_pdone_7:
  s_mov_b64 exec, -1
  s_add_u32 m0, s25, 0
  s_add_u32 s60, s24, 0
  buffer_load_dwordx4 v204, s[36:39], s60 offen sc1 lds
  s_add_u32 m0, s25, 4096
  s_add_u32 s60, s24, 4096
  buffer_load_dwordx4 v204, s[36:39], s60 offen sc1 lds
  s_add_u32 m0, s25, 8192
  s_add_u32 s60, s24, 8192
  buffer_load_dwordx4 v204, s[36:39], s60 offen sc1 lds
  s_add_u32 m0, s25, 12288
  s_add_u32 s60, s24, 12288
  buffer_load_dwordx4 v204, s[36:39], s60 offen sc1 lds
  ds_read_b64_tr_b16 a[144:145], v249 offset:12288
  ds_read_b64_tr_b16 a[146:147], v249 offset:13824
  ds_read_b64_tr_b16 a[148:149], v249 offset:12320
  ds_read_b64_tr_b16 a[150:151], v249 offset:13856
  ds_read_b64_tr_b16 a[152:153], v249 offset:12352
  ds_read_b64_tr_b16 a[154:155], v249 offset:13888
  ds_read_b64_tr_b16 a[156:157], v249 offset:15360
  ds_read_b64_tr_b16 a[158:159], v249 offset:16896
  ds_read_b64_tr_b16 a[160:161], v249 offset:15392
  ds_read_b64_tr_b16 a[162:163], v249 offset:16928
  ds_read_b64_tr_b16 a[164:165], v249 offset:15424
  ds_read_b64_tr_b16 a[166:167], v249 offset:16960
  ds_read_b64_tr_b16 a[168:169], v249 offset:18432
  ds_read_b64_tr_b16 a[170:171], v249 offset:19968
  ds_read_b64_tr_b16 a[172:173], v249 offset:18464
  ds_read_b64_tr_b16 a[174:175], v249 offset:20000
  ds_read_b64_tr_b16 a[176:177], v249 offset:18496
  ds_read_b64_tr_b16 a[178:179], v249 offset:20032
  ds_read_b64_tr_b16 a[180:181], v249 offset:21504
  ds_read_b64_tr_b16 a[182:183], v249 offset:23040
  ds_read_b64_tr_b16 a[184:185], v249 offset:21536
  ds_read_b64_tr_b16 a[186:187], v249 offset:23072
  ds_read_b64_tr_b16 a[188:189], v249 offset:21568
  ds_read_b64_tr_b16 a[190:191], v249 offset:23104
  s_add_u32 m0, s25, 16384
  s_add_u32 s60, s24, 16384
  buffer_load_dwordx4 v204, s[36:39], s60 offen sc1 lds
  s_add_u32 m0, s25, 20480
  s_add_u32 s60, s24, 20480
  buffer_load_dwordx4 v204, s[36:39], s60 offen sc1 lds
  s_add_u32 m0, s25, 24576
  s_add_u32 s60, s24, 24576
  buffer_load_dwordx4 v204, s[36:39], s60 offen sc1 lds
  s_add_u32 m0, s25, 28672
  s_add_u32 s60, s24, 28672
  buffer_load_dwordx4 v204, s[36:39], s60 offen sc1 lds
  s_waitcnt lgkmcnt(0)
  v_mfma_f32_16x16x32_bf16 v[104:107], a[144:147], v[116:119], v[104:107]
  v_mfma_f32_16x16x32_bf16 v[108:111], a[148:151], v[116:119], v[108:111]
  v_mfma_f32_16x16x32_bf16 v[112:115], a[152:155], v[116:119], v[112:115]
  v_mfma_f32_16x16x32_bf16 v[104:107], a[156:159], v[116:119], v[104:107]
  v_mfma_f32_16x16x32_bf16 v[108:111], a[160:163], v[116:119], v[108:111]
  v_mfma_f32_16x16x32_bf16 v[112:115], a[164:167], v[116:119], v[112:115]
  v_mfma_f32_16x16x32_bf16 v[104:107], a[168:171], v[116:119], v[104:107]
  v_mfma_f32_16x16x32_bf16 v[108:111], a[172:175], v[116:119], v[108:111]
  v_mfma_f32_16x16x32_bf16 v[112:115], a[176:179], v[116:119], v[112:115]
  v_mfma_f32_16x16x32_bf16 v[104:107], a[180:183], v[116:119], v[104:107]
  v_mfma_f32_16x16x32_bf16 v[108:111], a[184:187], v[116:119], v[108:111]
  v_mfma_f32_16x16x32_bf16 v[112:115], a[188:191], v[116:119], v[112:115]
  s_waitcnt vmcnt(6)
  s_barrier
  ds_read_b64_tr_b16 v[56:57], v200 offset:0
  ds_read_b64_tr_b16 v[58:59], v200 offset:1024
  ds_read_b64_tr_b16 v[60:61], v201 offset:0
  ds_read_b64_tr_b16 v[62:63], v201 offset:1024
  ds_read_b64_tr_b16 v[64:65], v200 offset:2048
  ds_read_b64_tr_b16 v[66:67], v200 offset:3072
  ds_read_b64_tr_b16 v[68:69], v201 offset:2048
  ds_read_b64_tr_b16 v[70:71], v201 offset:3072
  s_waitcnt lgkmcnt(4)
  v_mfma_f32_16x16x32_bf16 v[8:11], a[0:3], v[56:59], 0
  v_mfma_f32_16x16x32_bf16 v[24:27], a[4:7], v[56:59], 0
  s_add_u32 m0, s25, 32768
  s_add_u32 s60, s24, 32768
  v_mfma_f32_16x16x32_bf16 v[40:43], a[8:11], v[56:59], 0
  ds_read_b64_tr_b16 v[72:73], v200 offset:4096
  ds_read_b64_tr_b16 v[74:75], v200 offset:5120
  buffer_load_dwordx4 v204, s[36:39], s60 offen sc1 lds
  v_mfma_f32_16x16x32_bf16 v[12:15], a[0:3], v[60:63], 0
  s_add_u32 m0, s25, 36864
  s_add_u32 s60, s24, 36864
  v_mfma_f32_16x16x32_bf16 v[28:31], a[4:7], v[60:63], 0
  buffer_load_dwordx4 v204, s[36:39], s60 offen sc1 lds
  v_mfma_f32_16x16x32_bf16 v[44:47], a[8:11], v[60:63], 0
  ds_read_b64_tr_b16 v[76:77], v201 offset:4096
  ds_read_b64_tr_b16 v[78:79], v201 offset:5120
  s_add_u32 m0, s25, 40960
  s_add_u32 s60, s24, 40960
  s_waitcnt lgkmcnt(4)
  v_mfma_f32_16x16x32_bf16 v[8:11], a[12:15], v[64:67], v[8:11]
  s_waitcnt vmcnt(6)
  s_barrier
  buffer_load_dwordx4 v204, s[36:39], s60 offen sc1 lds
  v_mfma_f32_16x16x32_bf16 v[24:27], a[16:19], v[64:67], v[24:27]
  s_add_u32 m0, s25, 45056
  s_add_u32 s60, s24, 45056
  v_mfma_f32_16x16x32_bf16 v[40:43], a[20:23], v[64:67], v[40:43]
  ds_read_b64_tr_b16 v[80:81], v200 offset:6144
  ds_read_b64_tr_b16 v[82:83], v200 offset:7168
  buffer_load_dwordx4 v204, s[36:39], s60 offen sc1 lds
  v_mfma_f32_16x16x32_bf16 v[12:15], a[12:15], v[68:71], v[12:15]
  s_add_u32 m0, s25, 49152
  s_add_u32 s60, s24, 49152
  v_mfma_f32_16x16x32_bf16 v[28:31], a[16:19], v[68:71], v[28:31]
  buffer_load_dwordx4 v204, s[36:39], s60 offen sc1 lds
  v_mfma_f32_16x16x32_bf16 v[44:47], a[20:23], v[68:71], v[44:47]
  ds_read_b64_tr_b16 v[84:85], v201 offset:6144
  ds_read_b64_tr_b16 v[86:87], v201 offset:7168
  s_add_u32 m0, s25, 53248
  s_add_u32 s60, s24, 53248
  s_waitcnt lgkmcnt(4)
  v_mfma_f32_16x16x32_bf16 v[8:11], a[24:27], v[72:75], v[8:11]
  buffer_load_dwordx4 v204, s[36:39], s60 offen sc1 lds
  v_mfma_f32_16x16x32_bf16 v[24:27], a[28:31], v[72:75], v[24:27]
  s_add_u32 m0, s25, 57344
  s_add_u32 s60, s24, 57344
  v_mfma_f32_16x16x32_bf16 v[40:43], a[32:35], v[72:75], v[40:43]
  ds_read_b64_tr_b16 v[88:89], v200 offset:8192
  ds_read_b64_tr_b16 v[90:91], v200 offset:9216
  buffer_load_dwordx4 v204, s[36:39], s60 offen sc1 lds
  v_mfma_f32_16x16x32_bf16 v[12:15], a[24:27], v[76:79], v[12:15]
  s_add_u32 m0, s25, 61440
  s_add_u32 s60, s24, 61440
  v_mfma_f32_16x16x32_bf16 v[28:31], a[28:31], v[76:79], v[28:31]
  buffer_load_dwordx4 v204, s[36:39], s60 offen sc1 lds
  v_mfma_f32_16x16x32_bf16 v[44:47], a[32:35], v[76:79], v[44:47]
  ds_read_b64_tr_b16 v[92:93], v200 offset:10240
  ds_read_b64_tr_b16 v[94:95], v200 offset:11264
  s_waitcnt lgkmcnt(4)
  v_mfma_f32_16x16x32_bf16 v[8:11], a[36:39], v[80:83], v[8:11]
  v_mfma_f32_16x16x32_bf16 v[24:27], a[40:43], v[80:83], v[24:27]
  s_waitcnt vmcnt(8)
  s_barrier
  v_mfma_f32_16x16x32_bf16 v[40:43], a[44:47], v[80:83], v[40:43]
  ds_read_b64_tr_b16 v[56:57], v202 offset:0
  ds_read_b64_tr_b16 v[58:59], v202 offset:1024
  v_mfma_f32_16x16x32_bf16 v[12:15], a[36:39], v[84:87], v[12:15]
  v_mfma_f32_16x16x32_bf16 v[28:31], a[40:43], v[84:87], v[28:31]
  ds_read_b64_tr_b16 v[60:61], v202 offset:2048
  ds_read_b64_tr_b16 v[62:63], v202 offset:3072
  v_mfma_f32_16x16x32_bf16 v[44:47], a[44:47], v[84:87], v[44:47]
  s_add_u32 m0, s8, 0
  s_add_u32 s60, s26, 0
  s_waitcnt lgkmcnt(4)
  v_mfma_f32_16x16x32_bf16 v[8:11], a[48:51], v[88:91], v[8:11]
  ds_read_b64_tr_b16 v[64:65], v200 offset:12288
  ds_read_b64_tr_b16 v[66:67], v200 offset:13312
  buffer_load_dwordx4 v205, s[44:47], s60 offen lds
  v_mfma_f32_16x16x32_bf16 v[24:27], a[52:55], v[88:91], v[24:27]
  v_mfma_f32_16x16x32_bf16 v[40:43], a[56:59], v[88:91], v[40:43]
  v_mfma_f32_16x16x32_bf16 v[8:11], a[60:63], v[92:95], v[8:11]
  ds_read_b64_tr_b16 v[68:69], v200 offset:14336
  ds_read_b64_tr_b16 v[70:71], v200 offset:15360
  v_mfma_f32_16x16x32_bf16 v[24:27], a[64:67], v[92:95], v[24:27]
  v_mfma_f32_16x16x32_bf16 v[40:43], a[68:71], v[92:95], v[40:43]
  buffer_load_dwordx4 v206, s[44:47], s60 offen offset:1024 lds
  s_waitcnt lgkmcnt(6)
  v_mfma_f32_16x16x32_bf16 v[96:99], v[56:59], v[56:59], 0
  ds_read_b64_tr_b16 v[72:73], v202 offset:4096
  ds_read_b64_tr_b16 v[74:75], v202 offset:5120
  v_mfma_f32_16x16x32_bf16 v[100:103], v[116:119], v[56:59], 0
  s_waitcnt lgkmcnt(6)
  v_mfma_f32_16x16x32_bf16 v[96:99], v[60:63], v[60:63], v[96:99]
  ds_read_b64_tr_b16 v[76:77], v202 offset:6144
  ds_read_b64_tr_b16 v[78:79], v202 offset:7168
  v_mfma_f32_16x16x32_bf16 v[100:103], v[116:119], v[60:63], v[100:103]
  s_add_u32 m0, s8, 2048
  s_add_u32 s60, s26, 16384
  s_waitcnt lgkmcnt(4)
  v_mfma_f32_16x16x32_bf16 v[8:11], a[72:75], v[64:67], v[8:11]
  ds_read_b64_tr_b16 v[80:81], v200 offset:16384
  ds_read_b64_tr_b16 v[82:83], v200 offset:17408
  buffer_load_dwordx4 v205, s[44:47], s60 offen lds
  v_mfma_f32_16x16x32_bf16 v[24:27], a[76:79], v[64:67], v[24:27]
  v_mfma_f32_16x16x32_bf16 v[40:43], a[80:83], v[64:67], v[40:43]
  v_mfma_f32_16x16x32_bf16 v[8:11], a[84:87], v[68:71], v[8:11]
  ds_read_b64_tr_b16 v[84:85], v200 offset:18432
  ds_read_b64_tr_b16 v[86:87], v200 offset:19456
  v_mfma_f32_16x16x32_bf16 v[24:27], a[88:91], v[68:71], v[24:27]
  v_mfma_f32_16x16x32_bf16 v[40:43], a[92:95], v[68:71], v[40:43]
  buffer_load_dwordx4 v206, s[44:47], s60 offen offset:1024 lds
  s_waitcnt lgkmcnt(6)
  v_mfma_f32_16x16x32_bf16 v[96:99], v[72:75], v[72:75], v[96:99]
  ds_read_b64_tr_b16 v[88:89], v202 offset:8192
  ds_read_b64_tr_b16 v[90:91], v202 offset:9216
  v_mfma_f32_16x16x32_bf16 v[100:103], v[116:119], v[72:75], v[100:103]
  s_waitcnt lgkmcnt(6)
  v_mfma_f32_16x16x32_bf16 v[96:99], v[76:79], v[76:79], v[96:99]
  ds_read_b64_tr_b16 v[92:93], v202 offset:10240
  ds_read_b64_tr_b16 v[94:95], v202 offset:11264
  v_mfma_f32_16x16x32_bf16 v[100:103], v[116:119], v[76:79], v[100:103]
  s_add_u32 m0, s8, 4096
  s_add_u32 s60, s26, 49152
  s_waitcnt lgkmcnt(4)
  v_mfma_f32_16x16x32_bf16 v[8:11], a[96:99], v[80:83], v[8:11]
  ds_read_b64_tr_b16 v[56:57], v200 offset:20480
  ds_read_b64_tr_b16 v[58:59], v200 offset:21504
  buffer_load_dwordx4 v205, s[44:47], s60 offen lds
  v_mfma_f32_16x16x32_bf16 v[24:27], a[100:103], v[80:83], v[24:27]
  v_mfma_f32_16x16x32_bf16 v[40:43], a[104:107], v[80:83], v[40:43]
  v_mfma_f32_16x16x32_bf16 v[8:11], a[108:111], v[84:87], v[8:11]
  ds_read_b64_tr_b16 v[60:61], v200 offset:22528
  ds_read_b64_tr_b16 v[62:63], v200 offset:23552
  v_mfma_f32_16x16x32_bf16 v[24:27], a[112:115], v[84:87], v[24:27]
  v_mfma_f32_16x16x32_bf16 v[40:43], a[116:119], v[84:87], v[40:43]
  buffer_load_dwordx4 v206, s[44:47], s60 offen offset:1024 lds
  s_waitcnt lgkmcnt(6)
  v_mfma_f32_16x16x32_bf16 v[96:99], v[88:91], v[88:91], v[96:99]
  ds_read_b64_tr_b16 v[64:65], v202 offset:12288
  ds_read_b64_tr_b16 v[66:67], v202 offset:13312
  v_mfma_f32_16x16x32_bf16 v[100:103], v[116:119], v[88:91], v[100:103]
  s_waitcnt lgkmcnt(6)
  v_mfma_f32_16x16x32_bf16 v[96:99], v[92:95], v[92:95], v[96:99]
  ds_read_b64_tr_b16 v[68:69], v202 offset:14336
  ds_read_b64_tr_b16 v[70:71], v202 offset:15360
  v_mfma_f32_16x16x32_bf16 v[100:103], v[116:119], v[92:95], v[100:103]
  s_add_u32 m0, s8, 6144
  s_add_u32 s60, s26, 65536
  s_waitcnt lgkmcnt(4)
  v_mfma_f32_16x16x32_bf16 v[8:11], a[120:123], v[56:59], v[8:11]
  ds_read_b64_tr_b16 v[72:73], v200 offset:24576
  ds_read_b64_tr_b16 v[74:75], v200 offset:25600
  buffer_load_dwordx4 v205, s[44:47], s60 offen lds
  v_mfma_f32_16x16x32_bf16 v[24:27], a[124:127], v[56:59], v[24:27]
  v_mfma_f32_16x16x32_bf16 v[40:43], a[128:131], v[56:59], v[40:43]
  v_mfma_f32_16x16x32_bf16 v[8:11], a[132:135], v[60:63], v[8:11]
  ds_read_b64_tr_b16 v[76:77], v200 offset:26624
  ds_read_b64_tr_b16 v[78:79], v200 offset:27648
  v_mfma_f32_16x16x32_bf16 v[24:27], a[136:139], v[60:63], v[24:27]
  v_mfma_f32_16x16x32_bf16 v[40:43], a[140:143], v[60:63], v[40:43]
  buffer_load_dwordx4 v206, s[44:47], s60 offen offset:1024 lds
  s_waitcnt lgkmcnt(6)
  v_mfma_f32_16x16x32_bf16 v[96:99], v[64:67], v[64:67], v[96:99]
  ds_read_b64_tr_b16 v[80:81], v200 offset:28672
  ds_read_b64_tr_b16 v[82:83], v200 offset:29696
  v_mfma_f32_16x16x32_bf16 v[100:103], v[116:119], v[64:67], v[100:103]
  s_waitcnt lgkmcnt(6)
  v_mfma_f32_16x16x32_bf16 v[96:99], v[68:71], v[68:71], v[96:99]
  v_mfma_f32_16x16x32_bf16 v[100:103], v[116:119], v[68:71], v[100:103]
  ds_read_b64_tr_b16 v[84:85], v200 offset:30720
  ds_read_b64_tr_b16 v[86:87], v200 offset:31744
  s_add_u32 m0, s8, 8192
  s_add_u32 s60, s26, 98304
  s_waitcnt lgkmcnt(4)
  v_mfma_f32_16x16x32_bf16 v[8:11], a[144:147], v[72:75], v[8:11]
  buffer_load_dwordx4 v205, s[44:47], s60 offen lds
  v_mfma_f32_16x16x32_bf16 v[24:27], a[148:151], v[72:75], v[24:27]
  v_mfma_f32_16x16x32_bf16 v[40:43], a[152:155], v[72:75], v[40:43]
  ds_read_b64_tr_b16 v[88:89], v201 offset:8192
  ds_read_b64_tr_b16 v[90:91], v201 offset:9216
  v_mfma_f32_16x16x32_bf16 v[8:11], a[156:159], v[76:79], v[8:11]
  v_mfma_f32_16x16x32_bf16 v[24:27], a[160:163], v[76:79], v[24:27]
  v_mfma_f32_16x16x32_bf16 v[40:43], a[164:167], v[76:79], v[40:43]
  ds_read_b64_tr_b16 v[92:93], v201 offset:10240
  ds_read_b64_tr_b16 v[94:95], v201 offset:11264
  buffer_load_dwordx4 v206, s[44:47], s60 offen offset:1024 lds
  s_waitcnt lgkmcnt(4)
  v_mfma_f32_16x16x32_bf16 v[8:11], a[168:171], v[80:83], v[8:11]
  v_cndmask_b32 v96, v96, v97, s[16:17]
  s_lshl_b32 s4, s59, 8
  v_mfma_f32_16x16x32_bf16 v[24:27], a[172:175], v[80:83], v[24:27]
  s_lshl_b32 s5, s58, 3
  v_cndmask_b32 v96, v96, v98, s[18:19]
  v_mfma_f32_16x16x32_bf16 v[40:43], a[176:179], v[80:83], v[40:43]
  ds_read_b64_tr_b16 v[56:57], v201 offset:12288
  ds_read_b64_tr_b16 v[58:59], v201 offset:13312
  s_add_u32 s4, s4, s5
  v_add_u32 v2, s4, v207
  v_mfma_f32_16x16x32_bf16 v[8:11], a[180:183], v[84:87], v[8:11]
  v_cndmask_b32 v101, v96, v99, s[20:21]
  s_add_u32 m0, s8, 10240
  s_add_u32 s60, s26, 114688
  v_mfma_f32_16x16x32_bf16 v[24:27], a[184:187], v[84:87], v[24:27]
  s_mov_b64 exec, s[22:23]
  ds_write_b64 v2, v[100:101] offset:0
  s_mov_b64 exec, -1
  buffer_load_dwordx4 v205, s[44:47], s60 offen lds
  v_mfma_f32_16x16x32_bf16 v[40:43], a[188:191], v[84:87], v[40:43]
  ds_read_b64_tr_b16 v[60:61], v201 offset:14336
  ds_read_b64_tr_b16 v[62:63], v201 offset:15360
  s_waitcnt lgkmcnt(5)
  v_mfma_f32_16x16x32_bf16 v[12:15], a[48:51], v[88:91], v[12:15]
  v_mfma_f32_16x16x32_bf16 v[28:31], a[52:55], v[88:91], v[28:31]
  v_mfma_f32_16x16x32_bf16 v[44:47], a[56:59], v[88:91], v[44:47]
  s_waitcnt vmcnt(11)
  s_barrier
  ds_read_b64_tr_b16 v[64:65], v201 offset:16384
  ds_read_b64_tr_b16 v[66:67], v201 offset:17408
  s_waitcnt lgkmcnt(4)
  s_barrier
  ds_read_b128 v[136:139], v207 offset:0
  ds_read_b128 v[140:143], v207 offset:256
  v_mfma_f32_16x16x32_bf16 v[12:15], a[60:63], v[92:95], v[12:15]
  buffer_load_dwordx4 v206, s[44:47], s60 offen offset:1024 lds
  v_mfma_f32_16x16x32_bf16 v[28:31], a[64:67], v[92:95], v[28:31]
  v_mfma_f32_16x16x32_bf16 v[44:47], a[68:71], v[92:95], v[44:47]
  ds_read_b64_tr_b16 v[68:69], v201 offset:18432
  ds_read_b64_tr_b16 v[70:71], v201 offset:19456
  s_waitcnt lgkmcnt(6)
  v_mfma_f32_16x16x32_bf16 v[12:15], a[72:75], v[56:59], v[12:15]
  v_mfma_f32_16x16x32_bf16 v[28:31], a[76:79], v[56:59], v[28:31]
  s_add_u32 m0, s8, 12288
  s_add_u32 s60, s26, 147456
  s_waitcnt lgkmcnt(2)
  v_mfma_f32_16x16x32_bf16 v[44:47], a[80:83], v[56:59], v[44:47]
  ds_read_b64_tr_b16 v[72:73], v202 offset:32768
  ds_read_b64_tr_b16 v[74:75], v202 offset:33792
  v_add_f32 v136, v136, v138
  v_add_f32 v137, v137, v139
  buffer_load_dwordx4 v205, s[44:47], s60 offen lds
  v_mfma_f32_16x16x32_bf16 v[12:15], a[84:87], v[60:63], v[12:15]
  v_mul_f32 v120, 0xbb000000, v136
  v_mul_f32 v137, 0x3b000000, v137
  v_mfma_f32_16x16x32_bf16 v[28:31], a[88:91], v[60:63], v[28:31]
  ds_read_b64_tr_b16 v[76:77], v201 offset:20480
  ds_read_b64_tr_b16 v[78:79], v201 offset:21504
  v_fma_f32 v137, -v120, v120, v137
  v_max_f32 v137, 0, v137
  v_mfma_f32_16x16x32_bf16 v[44:47], a[92:95], v[60:63], v[44:47]
  v_add_f32 v137, 0x3727c5ac, v137
  v_rsq_f32 v121, v137
  s_waitcnt lgkmcnt(4)
  v_mfma_f32_16x16x32_bf16 v[12:15], a[96:99], v[64:67], v[12:15]
  v_sqrt_f32 v122, v137
  v_mul_f32 v121, 0xbfb8aa3b, v121
  v_mfma_f32_16x16x32_bf16 v[28:31], a[100:103], v[64:67], v[28:31]
  ds_read_b64_tr_b16 v[80:81], v201 offset:22528
  ds_read_b64_tr_b16 v[82:83], v201 offset:23552
  v_add_f32 v140, v140, v142
  v_add_f32 v141, v141, v143
  buffer_load_dwordx4 v206, s[44:47], s60 offen offset:1024 lds
  v_mfma_f32_16x16x32_bf16 v[44:47], a[104:107], v[64:67], v[44:47]
  v_mul_f32 v124, 0xbb000000, v140
  v_mul_f32 v141, 0x3b000000, v141
  v_mfma_f32_16x16x32_bf16 v[12:15], a[108:111], v[68:71], v[12:15]
  v_fma_f32 v141, -v124, v124, v141
  v_max_f32 v141, 0, v141
  v_mfma_f32_16x16x32_bf16 v[28:31], a[112:115], v[68:71], v[28:31]
  ds_read_b64_tr_b16 v[84:85], v202 offset:34816
  ds_read_b64_tr_b16 v[86:87], v202 offset:35840
  v_add_f32 v141, 0x3727c5ac, v141
  v_rsq_f32 v125, v141
  v_mfma_f32_16x16x32_bf16 v[44:47], a[116:119], v[68:71], v[44:47]
  v_sqrt_f32 v126, v141
  v_mul_f32 v125, 0xbfb8aa3b, v125
  s_add_u32 m0, s8, 14336
  s_add_u32 s60, s26, 163840
  s_waitcnt lgkmcnt(6)
  v_mfma_f32_16x16x32_bf16 v[96:99], v[72:75], v[72:75], 0
  ds_read_b64_tr_b16 v[88:89], v201 offset:24576
  ds_read_b64_tr_b16 v[90:91], v201 offset:25600
  buffer_load_dwordx4 v205, s[44:47], s60 offen lds
  v_fmac_f32 v8, v104, v120
  v_fmac_f32 v9, v105, v120
  v_mfma_f32_16x16x32_bf16 v[100:103], v[116:119], v[72:75], 0
  v_fmac_f32 v10, v106, v120
  v_fmac_f32 v11, v107, v120
  v_fmac_f32 v24, v108, v120
  v_fmac_f32 v25, v109, v120
  s_waitcnt lgkmcnt(4)
  v_mfma_f32_16x16x32_bf16 v[12:15], a[120:123], v[76:79], v[12:15]
  v_xor_b32 v2, 32, v203
  ds_read_b64_tr_b16 v[180:181], v203 offset:0
  ds_read_b64_tr_b16 v[182:183], v2 offset:0
  ds_read_b64_tr_b16 v[184:185], v203 offset:32768
  ds_read_b64_tr_b16 v[186:187], v2 offset:32768
  v_mfma_f32_16x16x32_bf16 v[28:31], a[124:127], v[76:79], v[28:31]
  ds_read_b64_tr_b16 v[92:93], v201 offset:26624
  ds_read_b64_tr_b16 v[94:95], v201 offset:27648
  v_fmac_f32 v26, v110, v120
  v_fmac_f32 v27, v111, v120
  v_mfma_f32_16x16x32_bf16 v[44:47], a[128:131], v[76:79], v[44:47]
  v_fmac_f32 v40, v112, v120
  v_fmac_f32 v41, v113, v120
  v_fmac_f32 v42, v114, v120
  v_fmac_f32 v43, v115, v120
  v_mul_f32 v144, v121, v8
  v_mfma_f32_16x16x32_bf16 v[12:15], a[132:135], v[80:83], v[12:15]
  buffer_load_dwordx4 v206, s[44:47], s60 offen offset:1024 lds
  v_mul_f32 v145, v121, v9
  v_mul_f32 v146, v121, v10
  v_mul_f32 v147, v121, v11
  v_mul_f32 v148, v121, v24
  v_mfma_f32_16x16x32_bf16 v[28:31], a[136:139], v[80:83], v[28:31]
  ds_read_b64_tr_b16 v[56:57], v202 offset:36864
  ds_read_b64_tr_b16 v[58:59], v202 offset:37888
  v_mul_f32 v149, v121, v25
  v_mul_f32 v150, v121, v26
  v_mul_f32 v151, v121, v27
  v_mfma_f32_16x16x32_bf16 v[44:47], a[140:143], v[80:83], v[44:47]
  v_mul_f32 v152, v121, v40
  v_mul_f32 v153, v121, v41
  v_mul_f32 v154, v121, v42
  v_mul_f32 v155, v121, v43
  s_waitcnt lgkmcnt(10)
  v_mfma_f32_16x16x32_bf16 v[96:99], v[84:87], v[84:87], v[96:99]
  ds_read_b64_tr_b16 v[60:61], v201 offset:28672
  ds_read_b64_tr_b16 v[62:63], v201 offset:29696
  v_exp_f32 v144, v144
  v_mfma_f32_16x16x32_bf16 v[100:103], v[116:119], v[84:87], v[100:103]
  s_add_u32 m0, s8, 16384
  s_add_u32 s60, s26, 180224
  v_exp_f32 v145, v145
  s_waitcnt lgkmcnt(4)
  v_mfma_f32_16x16x32_bf16 v[12:15], a[144:147], v[88:91], v[12:15]
  buffer_load_dwordx4 v205, s[44:47], s60 offen lds
  v_exp_f32 v146, v146
  v_exp_f32 v147, v147
  v_mfma_f32_16x16x32_bf16 v[28:31], a[148:151], v[88:91], v[28:31]
  ds_read_b64_tr_b16 v[64:65], v201 offset:30720
  ds_read_b64_tr_b16 v[66:67], v201 offset:31744
  v_exp_f32 v148, v148
  v_mfma_f32_16x16x32_bf16 v[44:47], a[152:155], v[88:91], v[44:47]
  v_exp_f32 v149, v149
  v_exp_f32 v150, v150
  v_mfma_f32_16x16x32_bf16 v[12:15], a[156:159], v[92:95], v[12:15]
  v_exp_f32 v151, v151
  v_exp_f32 v152, v152
  v_mfma_f32_16x16x32_bf16 v[28:31], a[160:163], v[92:95], v[28:31]
  ds_read_b64_tr_b16 v[68:69], v202 offset:38912
  ds_read_b64_tr_b16 v[70:71], v202 offset:39936
  v_exp_f32 v153, v153
  v_exp_f32 v154, v154
  v_mfma_f32_16x16x32_bf16 v[44:47], a[164:167], v[92:95], v[44:47]
  buffer_load_dwordx4 v206, s[44:47], s60 offen offset:1024 lds
  v_exp_f32 v155, v155
  v_fma_f32 v144, v144, v122, v122
  s_waitcnt lgkmcnt(6)
  v_mfma_f32_16x16x32_bf16 v[96:99], v[56:59], v[56:59], v[96:99]
  ds_read_b64_tr_b16 v[72:73], v200 offset:32768
  ds_read_b64_tr_b16 v[74:75], v200 offset:33792
  v_fma_f32 v145, v145, v122, v122
  v_fma_f32 v146, v146, v122, v122
  v_fma_f32 v147, v147, v122, v122
  v_mfma_f32_16x16x32_bf16 v[100:103], v[116:119], v[56:59], v[100:103]
  v_fma_f32 v148, v148, v122, v122
  v_fma_f32 v149, v149, v122, v122
  v_fma_f32 v150, v150, v122, v122
  v_fma_f32 v151, v151, v122, v122
  s_waitcnt lgkmcnt(4)
  v_mfma_f32_16x16x32_bf16 v[12:15], a[168:171], v[60:63], v[12:15]
  v_fma_f32 v152, v152, v122, v122
  v_fma_f32 v153, v153, v122, v122
  v_fma_f32 v154, v154, v122, v122
  v_fma_f32 v155, v155, v122, v122
  v_mfma_f32_16x16x32_bf16 v[28:31], a[172:175], v[60:63], v[28:31]
  ds_read_b64_tr_b16 v[76:77], v200 offset:34816
  ds_read_b64_tr_b16 v[78:79], v200 offset:35840
  s_add_u32 m0, s8, 18432
  s_add_u32 s60, s26, 196608
  v_mfma_f32_16x16x32_bf16 v[44:47], a[176:179], v[60:63], v[44:47]
  buffer_load_dwordx4 v205, s[44:47], s60 offen lds
  v_rcp_f32 v144, v144
  v_rcp_f32 v145, v145
  v_mfma_f32_16x16x32_bf16 v[12:15], a[180:183], v[64:67], v[12:15]
  v_rcp_f32 v146, v146
  v_rcp_f32 v147, v147
  v_rcp_f32 v148, v148
  v_mfma_f32_16x16x32_bf16 v[28:31], a[184:187], v[64:67], v[28:31]
  ds_read_b64_tr_b16 v[80:81], v202 offset:40960
  ds_read_b64_tr_b16 v[82:83], v202 offset:41984
  v_rcp_f32 v149, v149
  v_mfma_f32_16x16x32_bf16 v[44:47], a[188:191], v[64:67], v[44:47]
  v_rcp_f32 v150, v150
  v_rcp_f32 v151, v151
  s_waitcnt lgkmcnt(6)
  v_mfma_f32_16x16x32_bf16 v[96:99], v[68:71], v[68:71], v[96:99]
  ds_read_b64_tr_b16 v[84:85], v200 offset:36864
  ds_read_b64_tr_b16 v[86:87], v200 offset:37888
  v_rcp_f32 v152, v152
  v_mfma_f32_16x16x32_bf16 v[100:103], v[116:119], v[68:71], v[100:103]
  buffer_load_dwordx4 v206, s[44:47], s60 offen offset:1024 lds
  v_rcp_f32 v153, v153
  s_waitcnt lgkmcnt(4)
  v_mfma_f32_16x16x32_bf16 v[16:19], a[0:3], v[72:75], 0
  v_rcp_f32 v154, v154
  v_rcp_f32 v155, v155
  v_mul_f32 v8, v8, v144
  v_mul_f32 v9, v9, v145
  v_mfma_f32_16x16x32_bf16 v[32:35], a[4:7], v[72:75], 0
  ds_read_b64_tr_b16 v[88:89], v200 offset:38912
  ds_read_b64_tr_b16 v[90:91], v200 offset:39936
  v_mul_f32 v10, v10, v146
  v_mul_f32 v11, v11, v147
  v_mul_f32 v24, v24, v148
  v_mfma_f32_16x16x32_bf16 v[48:51], a[8:11], v[72:75], 0
  v_mul_f32 v25, v25, v149
  v_mul_f32 v26, v26, v150
  v_mul_f32 v27, v27, v151
  v_mul_f32 v40, v40, v152
  v_mfma_f32_16x16x32_bf16 v[16:19], a[12:15], v[76:79], v[16:19]
  v_mul_f32 v41, v41, v153
  v_mul_f32 v42, v42, v154
  v_mul_f32 v43, v43, v155
  v_cvt_pk_bf16_f32 v156, v8, v9
  v_cvt_pk_bf16_f32 v157, v10, v11
  v_mfma_f32_16x16x32_bf16 v[32:35], a[16:19], v[76:79], v[32:35]
  ds_read_b64_tr_b16 v[92:93], v202 offset:43008
  ds_read_b64_tr_b16 v[94:95], v202 offset:44032
  s_waitcnt vmcnt(8)
  ds_read_b64_tr_b16 a[192:193], v212 offset:0
  v_cvt_pk_bf16_f32 v158, v24, v25
  v_mfma_f32_16x16x32_bf16 v[48:51], a[20:23], v[76:79], v[48:51]
  ds_read_b64_tr_b16 a[194:195], v212 offset:2048
  v_cvt_pk_bf16_f32 v159, v26, v27
  v_cvt_pk_bf16_f32 v172, v40, v41
  v_cvt_pk_bf16_f32 v173, v42, v43
  s_waitcnt lgkmcnt(8)
  v_mfma_f32_16x16x32_bf16 v[96:99], v[80:83], v[80:83], v[96:99]
  ds_read_b64_tr_b16 v[56:57], v200 offset:40960
  ds_read_b64_tr_b16 v[58:59], v200 offset:41984
  ds_read_b64_tr_b16 a[196:197], v213 offset:0
  buffer_store_dwordx4 v[156:159], v255, s[36:39], s29 offen offset:0 sc1
  v_mfma_f32_16x16x32_bf16 v[100:103], v[116:119], v[80:83], v[100:103]
  ds_read_b64_tr_b16 a[198:199], v213 offset:2048
  s_waitcnt lgkmcnt(8)
  v_mfma_f32_16x16x32_bf16 v[16:19], a[24:27], v[84:87], v[16:19]
  ds_read_b64_tr_b16 a[200:201], v214 offset:0
  s_barrier
  s_add_u32 m0, s27, 0
  s_add_u32 s60, s26, 229376
  v_fmac_f32 v12, v104, v124
  v_mfma_f32_16x16x32_bf16 v[32:35], a[28:31], v[84:87], v[32:35]
  ds_read_b64_tr_b16 v[60:61], v200 offset:43008
  ds_read_b64_tr_b16 v[62:63], v200 offset:44032
  ds_read_b64_tr_b16 a[202:203], v214 offset:2048
  buffer_load_dwordx4 v205, s[44:47], s60 offen lds
  v_fmac_f32 v13, v105, v124
  v_mfma_f32_16x16x32_bf16 v[48:51], a[32:35], v[84:87], v[48:51]
  ds_read_b64_tr_b16 a[204:205], v215 offset:0
  v_fmac_f32 v14, v106, v124
  v_fmac_f32 v15, v107, v124
  v_fmac_f32 v28, v108, v124
  v_mfma_f32_16x16x32_bf16 v[16:19], a[36:39], v[88:91], v[16:19]
  ds_read_b64_tr_b16 a[206:207], v215 offset:2048
  v_fmac_f32 v29, v109, v124
  v_fmac_f32 v30, v110, v124
  v_fmac_f32 v31, v111, v124
  v_fmac_f32 v44, v112, v124
  v_mfma_f32_16x16x32_bf16 v[32:35], a[40:43], v[88:91], v[32:35]
  ds_read_b64_tr_b16 v[64:65], v202 offset:45056
  ds_read_b64_tr_b16 v[66:67], v202 offset:46080
  ds_read_b64_tr_b16 a[208:209], v212 offset:4096
  v_fmac_f32 v45, v113, v124
  v_fmac_f32 v46, v114, v124
  v_mfma_f32_16x16x32_bf16 v[48:51], a[44:47], v[88:91], v[48:51]
  ds_read_b64_tr_b16 a[210:211], v212 offset:6144
  v_fmac_f32 v47, v115, v124
  v_mul_f32 v144, v125, v12
  v_mul_f32 v145, v125, v13
  s_waitcnt lgkmcnt(15)
  v_mfma_f32_16x16x32_bf16 v[96:99], v[92:95], v[92:95], v[96:99]
  ds_read_b64_tr_b16 v[68:69], v200 offset:45056
  ds_read_b64_tr_b16 v[70:71], v200 offset:46080
  ds_read_b64_tr_b16 a[212:213], v213 offset:4096
  buffer_load_dwordx4 v206, s[44:47], s60 offen offset:1024 lds
  v_mul_f32 v146, v125, v14
  v_mfma_f32_16x16x32_bf16 v[100:103], v[116:119], v[92:95], v[100:103]
  ds_read_b64_tr_b16 a[214:215], v213 offset:6144
  v_mul_f32 v147, v125, v15
  v_mul_f32 v148, v125, v28
  s_waitcnt lgkmcnt(11)
  v_mfma_f32_16x16x32_bf16 v[16:19], a[48:51], v[56:59], v[16:19]
  ds_read_b64_tr_b16 a[216:217], v214 offset:4096
  v_mul_f32 v149, v125, v29
  v_mul_f32 v150, v125, v30
  v_mul_f32 v151, v125, v31
  v_mul_f32 v152, v125, v44
  v_mfma_f32_16x16x32_bf16 v[32:35], a[52:55], v[56:59], v[32:35]
  ds_read_b64_tr_b16 v[72:73], v200 offset:47104
  ds_read_b64_tr_b16 v[74:75], v200 offset:48128
  ds_read_b64_tr_b16 a[218:219], v214 offset:6144
  v_mul_f32 v153, v125, v45
  v_mul_f32 v154, v125, v46
  v_mfma_f32_16x16x32_bf16 v[48:51], a[56:59], v[56:59], v[48:51]
  ds_read_b64_tr_b16 a[220:221], v215 offset:4096
  s_add_u32 m0, s27, 2048
  s_add_u32 s60, s26, 245760
  v_mul_f32 v155, v125, v47
  v_mfma_f32_16x16x32_bf16 v[16:19], a[60:63], v[60:63], v[16:19]
  ds_read_b64_tr_b16 a[222:223], v215 offset:6144
  buffer_load_dwordx4 v205, s[44:47], s60 offen lds
  v_exp_f32 v144, v144
  v_mfma_f32_16x16x32_bf16 v[32:35], a[64:67], v[60:63], v[32:35]
  ds_read_b64_tr_b16 v[76:77], v202 offset:47104
  ds_read_b64_tr_b16 v[78:79], v202 offset:48128
  ds_read_b64_tr_b16 a[224:225], v212 offset:8192
  v_exp_f32 v145, v145
  v_mfma_f32_16x16x32_bf16 v[48:51], a[68:71], v[60:63], v[48:51]
  ds_read_b64_tr_b16 a[226:227], v212 offset:10240
  v_exp_f32 v146, v146
  s_waitcnt lgkmcnt(15)
  v_mfma_f32_16x16x32_bf16 v[96:99], v[64:67], v[64:67], v[96:99]
  ds_read_b64_tr_b16 v[80:81], v200 offset:49152
  ds_read_b64_tr_b16 v[82:83], v200 offset:50176
  ds_read_b64_tr_b16 a[228:229], v213 offset:8192
  v_exp_f32 v147, v147
  v_mfma_f32_16x16x32_bf16 v[100:103], v[116:119], v[64:67], v[100:103]
  ds_read_b64_tr_b16 a[230:231], v213 offset:10240
  v_exp_f32 v148, v148
  v_exp_f32 v149, v149
  s_waitcnt lgkmcnt(11)
  v_mfma_f32_16x16x32_bf16 v[16:19], a[72:75], v[68:71], v[16:19]
  ds_read_b64_tr_b16 a[232:233], v214 offset:8192
  buffer_load_dwordx4 v206, s[44:47], s60 offen offset:1024 lds
  v_exp_f32 v150, v150
  v_mfma_f32_16x16x32_bf16 v[32:35], a[76:79], v[68:71], v[32:35]
  ds_read_b64_tr_b16 v[84:85], v200 offset:51200
  ds_read_b64_tr_b16 v[86:87], v200 offset:52224
  ds_read_b64_tr_b16 a[234:235], v214 offset:10240
  v_exp_f32 v151, v151
  v_mfma_f32_16x16x32_bf16 v[48:51], a[80:83], v[68:71], v[48:51]
  ds_read_b64_tr_b16 a[236:237], v215 offset:8192
  v_exp_f32 v152, v152
  v_exp_f32 v153, v153
  v_mfma_f32_16x16x32_bf16 v[16:19], a[84:87], v[72:75], v[16:19]
  ds_read_b64_tr_b16 a[238:239], v215 offset:10240
  v_exp_f32 v154, v154
  v_exp_f32 v155, v155
  v_mfma_f32_16x16x32_bf16 v[32:35], a[88:91], v[72:75], v[32:35]
  ds_read_b64_tr_b16 v[88:89], v200 offset:53248
  ds_read_b64_tr_b16 v[90:91], v200 offset:54272
  s_add_u32 m0, s27, 4096
  s_add_u32 s60, s26, 278528
  v_fma_f32 v144, v144, v126, v126
  v_mfma_f32_16x16x32_bf16 v[48:51], a[92:95], v[72:75], v[48:51]
  buffer_load_dwordx4 v205, s[44:47], s60 offen lds
  v_fma_f32 v145, v145, v126, v126
  v_fma_f32 v146, v146, v126, v126
  v_fma_f32 v147, v147, v126, v126
  s_waitcnt lgkmcnt(14)
  v_mfma_f32_16x16x32_bf16 v[96:99], v[76:79], v[76:79], v[96:99]
  v_fma_f32 v148, v148, v126, v126
  v_fma_f32 v149, v149, v126, v126
  v_fma_f32 v150, v150, v126, v126
  v_fma_f32 v151, v151, v126, v126
  v_mfma_f32_16x16x32_bf16 v[100:103], v[116:119], v[76:79], v[100:103]
  ds_read_b64_tr_b16 v[92:93], v200 offset:55296
  ds_read_b64_tr_b16 v[94:95], v200 offset:56320
  v_fma_f32 v152, v152, v126, v126
  v_fma_f32 v153, v153, v126, v126
  s_waitcnt lgkmcnt(7)
  v_mfma_f32_16x16x32_bf16 v[16:19], a[96:99], v[80:83], v[16:19]
  v_fma_f32 v154, v154, v126, v126
  v_fma_f32 v155, v155, v126, v126
  v_rcp_f32 v144, v144
  v_mfma_f32_16x16x32_bf16 v[32:35], a[100:103], v[80:83], v[32:35]
  v_rcp_f32 v145, v145
  v_rcp_f32 v146, v146
  v_rcp_f32 v147, v147
  v_mfma_f32_16x16x32_bf16 v[48:51], a[104:107], v[80:83], v[48:51]
  ds_read_b64_tr_b16 v[56:57], v200 offset:57344
  ds_read_b64_tr_b16 v[58:59], v200 offset:58368
  buffer_load_dwordx4 v206, s[44:47], s60 offen offset:1024 lds
  v_rcp_f32 v148, v148
  v_mfma_f32_16x16x32_bf16 v[16:19], a[108:111], v[84:87], v[16:19]
  v_rcp_f32 v149, v149
  v_rcp_f32 v150, v150
  v_mfma_f32_16x16x32_bf16 v[32:35], a[112:115], v[84:87], v[32:35]
  v_rcp_f32 v151, v151
  v_rcp_f32 v152, v152
  v_mfma_f32_16x16x32_bf16 v[48:51], a[116:119], v[84:87], v[48:51]
  ds_read_b64_tr_b16 v[60:61], v200 offset:59392
  ds_read_b64_tr_b16 v[62:63], v200 offset:60416
  v_rcp_f32 v153, v153
  s_waitcnt lgkmcnt(4)
  v_mfma_f32_16x16x32_bf16 v[16:19], a[120:123], v[88:91], v[16:19]
  v_cndmask_b32 v96, v96, v97, s[16:17]
  s_lshl_b32 s4, s59, 8
  s_add_u32 m0, s27, 6144
  s_add_u32 s60, s26, 294912
  v_rcp_f32 v154, v154
  v_mfma_f32_16x16x32_bf16 v[32:35], a[124:127], v[88:91], v[32:35]
  s_lshl_b32 s5, s58, 3
  v_cndmask_b32 v96, v96, v98, s[18:19]
  buffer_load_dwordx4 v205, s[44:47], s60 offen lds
  v_rcp_f32 v155, v155
  v_mfma_f32_16x16x32_bf16 v[48:51], a[128:131], v[88:91], v[48:51]
  ds_read_b64_tr_b16 v[64:65], v200 offset:61440
  ds_read_b64_tr_b16 v[66:67], v200 offset:62464
  s_add_u32 s4, s4, s5
  v_add_u32 v2, s4, v207
  v_mfma_f32_16x16x32_bf16 v[16:19], a[132:135], v[92:95], v[16:19]
  v_cndmask_b32 v101, v96, v99, s[20:21]
  v_mul_f32 v12, v12, v144
  v_mul_f32 v13, v13, v145
  v_mul_f32 v14, v14, v146
  v_mul_f32 v15, v15, v147
  v_mfma_f32_16x16x32_bf16 v[32:35], a[136:139], v[92:95], v[32:35]
  s_mov_b64 exec, s[22:23]
  ds_write_b64 v2, v[100:101] offset:512
  s_mov_b64 exec, -1
  v_mul_f32 v28, v28, v148
  v_mul_f32 v29, v29, v149
  v_mfma_f32_16x16x32_bf16 v[48:51], a[140:143], v[92:95], v[48:51]
  ds_read_b64_tr_b16 v[68:69], v200 offset:63488
  ds_read_b64_tr_b16 v[70:71], v200 offset:64512
  v_mul_f32 v30, v30, v150
  v_mul_f32 v31, v31, v151
  s_waitcnt lgkmcnt(5)
  v_mfma_f32_16x16x32_bf16 v[16:19], a[144:147], v[56:59], v[16:19]
  buffer_load_dwordx4 v206, s[44:47], s60 offen offset:1024 lds
  v_mul_f32 v44, v44, v152
  v_mul_f32 v45, v45, v153
  v_mul_f32 v46, v46, v154
  v_mul_f32 v47, v47, v155
  v_mfma_f32_16x16x32_bf16 v[32:35], a[148:151], v[56:59], v[32:35]
  v_cvt_pk_bf16_f32 v160, v12, v13
  v_cvt_pk_bf16_f32 v161, v14, v15
  v_cvt_pk_bf16_f32 v162, v28, v29
  v_cvt_pk_bf16_f32 v163, v30, v31
  v_mfma_f32_16x16x32_bf16 v[48:51], a[152:155], v[56:59], v[48:51]
  ds_read_b64_tr_b16 v[72:73], v201 offset:32768
  ds_read_b64_tr_b16 v[74:75], v201 offset:33792
  s_waitcnt lgkmcnt(4)
  s_barrier
  ds_read_b128 v[136:139], v207 offset:512
  ds_read_b128 v[140:143], v207 offset:768
  v_mfma_f32_16x16x32_bf16 v[16:19], a[156:159], v[60:63], v[16:19]
  v_cvt_pk_bf16_f32 v174, v44, v45
  v_cvt_pk_bf16_f32 v175, v46, v47
  buffer_store_dwordx4 v[160:163], v255, s[36:39], s29 offen offset:1024 sc1
  buffer_store_dwordx4 v[172:175], v208, s[36:39], s30 offen offset:0 sc1
  v_mfma_f32_16x16x32_bf16 v[32:35], a[160:163], v[60:63], v[32:35]
  s_add_u32 m0, s8, 0
  s_add_u32 s60, s26, 32768
  v_mfma_f32_16x16x32_bf16 v[48:51], a[164:167], v[60:63], v[48:51]
  ds_read_b64_tr_b16 v[76:77], v201 offset:34816
  ds_read_b64_tr_b16 v[78:79], v201 offset:35840
  buffer_load_dwordx4 v205, s[44:47], s60 offen lds
  s_waitcnt lgkmcnt(6)
  v_mfma_f32_16x16x32_bf16 v[16:19], a[168:171], v[64:67], v[16:19]
  v_mfma_f32_16x16x32_bf16 v[32:35], a[172:175], v[64:67], v[32:35]
  s_waitcnt lgkmcnt(2)
  v_mfma_f32_16x16x32_bf16 v[48:51], a[176:179], v[64:67], v[48:51]
  ds_read_b64_tr_b16 v[80:81], v201 offset:36864
  ds_read_b64_tr_b16 v[82:83], v201 offset:37888
  v_add_f32 v136, v136, v138
  v_add_f32 v137, v137, v139
  v_mfma_f32_16x16x32_bf16 v[16:19], a[180:183], v[68:71], v[16:19]
  v_mul_f32 v128, 0xbb000000, v136
  v_mul_f32 v137, 0x3b000000, v137
  v_mfma_f32_16x16x32_bf16 v[32:35], a[184:187], v[68:71], v[32:35]
  v_fma_f32 v137, -v128, v128, v137
  v_max_f32 v137, 0, v137
  buffer_load_dwordx4 v206, s[44:47], s60 offen offset:1024 lds
  v_mfma_f32_16x16x32_bf16 v[48:51], a[188:191], v[68:71], v[48:51]
  ds_read_b64_tr_b16 v[84:85], v201 offset:38912
  ds_read_b64_tr_b16 v[86:87], v201 offset:39936
  v_add_f32 v137, 0x3727c5ac, v137
  v_rsq_f32 v129, v137
  s_waitcnt lgkmcnt(4)
  v_mfma_f32_16x16x32_bf16 v[20:23], a[0:3], v[72:75], 0
  v_sqrt_f32 v130, v137
  v_mul_f32 v129, 0xbfb8aa3b, v129
  v_mfma_f32_16x16x32_bf16 v[36:39], a[4:7], v[72:75], 0
  v_add_f32 v140, v140, v142
  v_add_f32 v141, v141, v143
  v_mfma_f32_16x16x32_bf16 v[52:55], a[8:11], v[72:75], 0
  ds_read_b64_tr_b16 v[88:89], v201 offset:40960
  ds_read_b64_tr_b16 v[90:91], v201 offset:41984
  v_mul_f32 v132, 0xbb000000, v140
  v_mul_f32 v141, 0x3b000000, v141
  s_add_u32 m0, s8, 2048
  s_add_u32 s60, s26, 81920
  v_mfma_f32_16x16x32_bf16 v[20:23], a[12:15], v[76:79], v[20:23]
  v_fma_f32 v141, -v132, v132, v141
  v_max_f32 v141, 0, v141
  buffer_load_dwordx4 v205, s[44:47], s60 offen lds
  v_mfma_f32_16x16x32_bf16 v[36:39], a[16:19], v[76:79], v[36:39]
  v_add_f32 v141, 0x3727c5ac, v141
  v_rsq_f32 v133, v141
  v_mfma_f32_16x16x32_bf16 v[52:55], a[20:23], v[76:79], v[52:55]
  ds_read_b64_tr_b16 v[92:93], v201 offset:43008
  ds_read_b64_tr_b16 v[94:95], v201 offset:44032
  v_sqrt_f32 v134, v141
  v_mul_f32 v133, 0xbfb8aa3b, v133
  s_waitcnt lgkmcnt(4)
  v_mfma_f32_16x16x32_bf16 v[20:23], a[24:27], v[80:83], v[20:23]
  v_mfma_f32_16x16x32_bf16 v[36:39], a[28:31], v[80:83], v[36:39]
  v_mfma_f32_16x16x32_bf16 v[52:55], a[32:35], v[80:83], v[52:55]
  ds_read_b64_tr_b16 v[56:57], v201 offset:45056
  ds_read_b64_tr_b16 v[58:59], v201 offset:46080
  buffer_load_dwordx4 v206, s[44:47], s60 offen offset:1024 lds
  v_fmac_f32 v16, v104, v128
  v_mfma_f32_16x16x32_bf16 v[20:23], a[36:39], v[84:87], v[20:23]
  v_fmac_f32 v17, v105, v128
  v_fmac_f32 v18, v106, v128
  v_fmac_f32 v19, v107, v128
  v_mfma_f32_16x16x32_bf16 v[36:39], a[40:43], v[84:87], v[36:39]
  v_fmac_f32 v32, v108, v128
  v_fmac_f32 v33, v109, v128
  v_fmac_f32 v34, v110, v128
  v_fmac_f32 v35, v111, v128
  v_mfma_f32_16x16x32_bf16 v[52:55], a[44:47], v[84:87], v[52:55]
  ds_read_b64_tr_b16 v[60:61], v201 offset:47104
  ds_read_b64_tr_b16 v[62:63], v201 offset:48128
  v_fmac_f32 v48, v112, v128
  s_waitcnt lgkmcnt(4)
  v_mfma_f32_16x16x32_bf16 v[20:23], a[48:51], v[88:91], v[20:23]
  s_add_u32 m0, s8, 4096
  s_add_u32 s60, s26, 212992
  v_fmac_f32 v49, v113, v128
  v_mfma_f32_16x16x32_bf16 v[36:39], a[52:55], v[88:91], v[36:39]
  buffer_load_dwordx4 v205, s[44:47], s60 offen lds
  v_fmac_f32 v50, v114, v128
  v_fmac_f32 v51, v115, v128
  v_mul_f32 v144, v129, v16
  v_mfma_f32_16x16x32_bf16 v[52:55], a[56:59], v[88:91], v[52:55]
  ds_read_b64_tr_b16 v[64:65], v201 offset:49152
  ds_read_b64_tr_b16 v[66:67], v201 offset:50176
  v_mul_f32 v145, v129, v17
  v_mfma_f32_16x16x32_bf16 v[20:23], a[60:63], v[92:95], v[20:23]
  v_mul_f32 v146, v129, v18
  v_mul_f32 v147, v129, v19
  v_mul_f32 v148, v129, v32
  v_mul_f32 v149, v129, v33
  v_mfma_f32_16x16x32_bf16 v[36:39], a[64:67], v[92:95], v[36:39]
  v_mul_f32 v150, v129, v34
  v_mul_f32 v151, v129, v35
  v_mul_f32 v152, v129, v48
  v_mfma_f32_16x16x32_bf16 v[52:55], a[68:71], v[92:95], v[52:55]
  ds_read_b64_tr_b16 v[68:69], v201 offset:51200
  ds_read_b64_tr_b16 v[70:71], v201 offset:52224
  v_mul_f32 v153, v129, v49
  s_waitcnt lgkmcnt(4)
  v_mfma_f32_16x16x32_bf16 v[20:23], a[72:75], v[56:59], v[20:23]
  buffer_load_dwordx4 v206, s[44:47], s60 offen offset:1024 lds
  v_mul_f32 v154, v129, v50
  v_mul_f32 v155, v129, v51
  v_mfma_f32_16x16x32_bf16 v[36:39], a[76:79], v[56:59], v[36:39]
  v_exp_f32 v144, v144
  v_exp_f32 v145, v145
  v_mfma_f32_16x16x32_bf16 v[52:55], a[80:83], v[56:59], v[52:55]
  ds_read_b64_tr_b16 v[72:73], v201 offset:53248
  ds_read_b64_tr_b16 v[74:75], v201 offset:54272
  v_exp_f32 v146, v146
  v_mfma_f32_16x16x32_bf16 v[20:23], a[84:87], v[60:63], v[20:23]
  v_exp_f32 v147, v147
  v_exp_f32 v148, v148
  v_mfma_f32_16x16x32_bf16 v[36:39], a[88:91], v[60:63], v[36:39]
  s_add_u32 m0, s8, 6144
  s_add_u32 s60, s26, 262144
  v_mfma_f32_16x16x32_bf16 v[52:55], a[92:95], v[60:63], v[52:55]
  ds_read_b64_tr_b16 v[76:77], v201 offset:55296
  ds_read_b64_tr_b16 v[78:79], v201 offset:56320
  buffer_load_dwordx4 v205, s[44:47], s60 offen lds
  s_waitcnt lgkmcnt(4)
  v_mfma_f32_16x16x32_bf16 v[20:23], a[96:99], v[64:67], v[20:23]
  s_lshl_b32 s61, s56, 7
  s_add_u32 s61, s61, 0xe80000
  v_mov_b32 v3, s55
  v_lshlrev_b32 v2, 15, v4

  s_waitcnt vmcnt(7)
  s_cmp_lg_u32 s54, 0
  s_barrier
  s_cbranch_scc1 L_nofl_8
  s_mov_b64 exec, 1
  buffer_store_dword v3, v2, s[36:39], s61 offen sc1

  s_mov_b64 exec, -1
L_nofl_8:
  v_exp_f32 v149, v149
  v_exp_f32 v150, v150
  v_mfma_f32_16x16x32_bf16 v[36:39], a[100:103], v[64:67], v[36:39]
  v_exp_f32 v151, v151
  v_exp_f32 v152, v152
  v_mfma_f32_16x16x32_bf16 v[52:55], a[104:107], v[64:67], v[52:55]
  ds_read_b64_tr_b16 v[80:81], v201 offset:57344
  ds_read_b64_tr_b16 v[82:83], v201 offset:58368
  v_exp_f32 v153, v153
  v_mfma_f32_16x16x32_bf16 v[20:23], a[108:111], v[68:71], v[20:23]
  v_exp_f32 v154, v154
  v_mfma_f32_16x16x32_bf16 v[36:39], a[112:115], v[68:71], v[36:39]
  buffer_load_dwordx4 v206, s[44:47], s60 offen offset:1024 lds
  v_exp_f32 v155, v155
  v_fma_f32 v144, v144, v130, v130
  v_fma_f32 v145, v145, v130, v130
  v_mfma_f32_16x16x32_bf16 v[52:55], a[116:119], v[68:71], v[52:55]
  ds_read_b64_tr_b16 v[84:85], v201 offset:59392
  ds_read_b64_tr_b16 v[86:87], v201 offset:60416
  v_fma_f32 v146, v146, v130, v130
  s_waitcnt lgkmcnt(4)
  v_mfma_f32_16x16x32_bf16 v[20:23], a[120:123], v[72:75], v[20:23]
  v_fma_f32 v147, v147, v130, v130
  v_fma_f32 v148, v148, v130, v130
  v_fma_f32 v149, v149, v130, v130
  v_mfma_f32_16x16x32_bf16 v[36:39], a[124:127], v[72:75], v[36:39]
  v_fma_f32 v150, v150, v130, v130
  v_fma_f32 v151, v151, v130, v130
  v_fma_f32 v152, v152, v130, v130
  v_fma_f32 v153, v153, v130, v130
  v_mfma_f32_16x16x32_bf16 v[52:55], a[128:131], v[72:75], v[52:55]
  ds_read_b64_tr_b16 v[88:89], v201 offset:61440
  ds_read_b64_tr_b16 v[90:91], v201 offset:62464
  s_add_u32 m0, s8, 8192
  s_add_u32 s60, s26, 131072
  v_mfma_f32_16x16x32_bf16 v[20:23], a[132:135], v[76:79], v[20:23]
  buffer_load_dwordx4 v205, s[44:47], s60 offen lds
  v_fma_f32 v154, v154, v130, v130
  v_fma_f32 v155, v155, v130, v130
  v_mfma_f32_16x16x32_bf16 v[36:39], a[136:139], v[76:79], v[36:39]
  v_rcp_f32 v144, v144
  v_rcp_f32 v145, v145
  v_mfma_f32_16x16x32_bf16 v[52:55], a[140:143], v[76:79], v[52:55]
  ds_read_b64_tr_b16 v[92:93], v201 offset:63488
  ds_read_b64_tr_b16 v[94:95], v201 offset:64512
  s_waitcnt lgkmcnt(4)
  v_mfma_f32_16x16x32_bf16 v[20:23], a[144:147], v[80:83], v[20:23]
  v_rcp_f32 v146, v146
  v_rcp_f32 v147, v147
  v_mfma_f32_16x16x32_bf16 v[36:39], a[148:151], v[80:83], v[36:39]
  v_rcp_f32 v148, v148
  v_rcp_f32 v149, v149
  v_mfma_f32_16x16x32_bf16 v[52:55], a[152:155], v[80:83], v[52:55]
  buffer_load_dwordx4 v206, s[44:47], s60 offen offset:1024 lds
  v_rcp_f32 v150, v150
  v_mfma_f32_16x16x32_bf16 v[20:23], a[156:159], v[84:87], v[20:23]
  v_rcp_f32 v151, v151
  v_rcp_f32 v152, v152
  v_mfma_f32_16x16x32_bf16 v[36:39], a[160:163], v[84:87], v[36:39]
  v_rcp_f32 v153, v153
  v_rcp_f32 v154, v154
  v_mfma_f32_16x16x32_bf16 v[52:55], a[164:167], v[84:87], v[52:55]
  v_rcp_f32 v155, v155
  s_waitcnt lgkmcnt(0)
  v_mfma_f32_16x16x32_bf16 v[20:23], a[168:171], v[88:91], v[20:23]
  v_mul_f32 v16, v16, v144
  v_mul_f32 v17, v17, v145
  v_mul_f32 v18, v18, v146
  v_mul_f32 v19, v19, v147
  v_mfma_f32_16x16x32_bf16 v[36:39], a[172:175], v[88:91], v[36:39]
  v_mul_f32 v32, v32, v148
  v_mul_f32 v33, v33, v149
  v_mul_f32 v34, v34, v150
  v_mul_f32 v35, v35, v151
  v_mfma_f32_16x16x32_bf16 v[52:55], a[176:179], v[88:91], v[52:55]
  v_mul_f32 v48, v48, v152
  v_mul_f32 v49, v49, v153
  v_mul_f32 v50, v50, v154
  v_mfma_f32_16x16x32_bf16 v[20:23], a[180:183], v[92:95], v[20:23]
  v_mul_f32 v51, v51, v155
  v_cvt_pk_bf16_f32 v164, v16, v17
  v_cvt_pk_bf16_f32 v165, v18, v19
  v_cvt_pk_bf16_f32 v166, v32, v33
  v_mfma_f32_16x16x32_bf16 v[36:39], a[184:187], v[92:95], v[36:39]
  v_cvt_pk_bf16_f32 v167, v34, v35
  v_cvt_pk_bf16_f32 v176, v48, v49
  v_cvt_pk_bf16_f32 v177, v50, v51
  buffer_store_dwordx4 v[164:167], v255, s[36:39], s29 offen offset:2048 sc1
  v_mfma_f32_16x16x32_bf16 v[52:55], a[188:191], v[92:95], v[52:55]
  s_cmp_eq_u32 s54, 3
  s_cbranch_scc1 L_no7
  s_add_u32 m0, s8, 20480
  s_add_u32 s60, s26, 327680
  buffer_load_dwordx4 v205, s[44:47], s60 offen lds
  buffer_load_dwordx4 v206, s[44:47], s60 offen offset:1024 lds
  s_add_u32 m0, s8, 22528
  s_add_u32 s60, s26, 344064
  buffer_load_dwordx4 v205, s[44:47], s60 offen lds
  buffer_load_dwordx4 v206, s[44:47], s60 offen offset:1024 lds
L_no7:
  s_mov_b64 exec, 3
  buffer_load_dword v233, v232, s[36:39], s14 offen sc1
  s_mov_b64 exec, -1
  s_nop 7
  v_pk_fma_f32 v[20:21], v[104:105], v[132:133], v[20:21] op_sel_hi:[1,0,1]
  v_pk_fma_f32 v[22:23], v[106:107], v[132:133], v[22:23] op_sel_hi:[1,0,1]
  v_pk_fma_f32 v[36:37], v[108:109], v[132:133], v[36:37] op_sel_hi:[1,0,1]
  v_pk_fma_f32 v[38:39], v[110:111], v[132:133], v[38:39] op_sel_hi:[1,0,1]
  v_pk_fma_f32 v[52:53], v[112:113], v[132:133], v[52:53] op_sel_hi:[1,0,1]
  v_pk_fma_f32 v[54:55], v[114:115], v[132:133], v[54:55] op_sel_hi:[1,0,1]
  v_pk_mul_f32 v[144:145], v[20:21], v[132:133] op_sel:[0,1] op_sel_hi:[1,1]
  v_pk_mul_f32 v[146:147], v[22:23], v[132:133] op_sel:[0,1] op_sel_hi:[1,1]
  v_pk_mul_f32 v[148:149], v[36:37], v[132:133] op_sel:[0,1] op_sel_hi:[1,1]
  v_pk_mul_f32 v[150:151], v[38:39], v[132:133] op_sel:[0,1] op_sel_hi:[1,1]
  v_pk_mul_f32 v[152:153], v[52:53], v[132:133] op_sel:[0,1] op_sel_hi:[1,1]
  v_pk_mul_f32 v[154:155], v[54:55], v[132:133] op_sel:[0,1] op_sel_hi:[1,1]
  v_exp_f32 v144, v144
  v_exp_f32 v145, v145
  s_add_u32 m0, s8, 10240
  s_add_u32 s60, s26, 311296
  buffer_load_dwordx4 v205, s[44:47], s60 offen lds
  v_exp_f32 v146, v146
  v_exp_f32 v147, v147
  v_exp_f32 v148, v148
  v_exp_f32 v149, v149
  v_exp_f32 v150, v150
  v_exp_f32 v151, v151
  v_exp_f32 v152, v152
  v_exp_f32 v153, v153
  v_exp_f32 v154, v154
  v_exp_f32 v155, v155
  v_pk_fma_f32 v[144:145], v[144:145], v[134:135], v[134:135] op_sel_hi:[1,0,0]
  v_pk_fma_f32 v[146:147], v[146:147], v[134:135], v[134:135] op_sel_hi:[1,0,0]
  v_pk_fma_f32 v[148:149], v[148:149], v[134:135], v[134:135] op_sel_hi:[1,0,0]
  v_pk_fma_f32 v[150:151], v[150:151], v[134:135], v[134:135] op_sel_hi:[1,0,0]
  buffer_load_dwordx4 v206, s[44:47], s60 offen offset:1024 lds
  v_pk_fma_f32 v[152:153], v[152:153], v[134:135], v[134:135] op_sel_hi:[1,0,0]
  v_pk_fma_f32 v[154:155], v[154:155], v[134:135], v[134:135] op_sel_hi:[1,0,0]
  v_rcp_f32 v144, v144
  v_rcp_f32 v145, v145
  v_rcp_f32 v146, v146
  v_rcp_f32 v147, v147
  v_rcp_f32 v148, v148
  v_rcp_f32 v149, v149
  v_rcp_f32 v150, v150
  v_rcp_f32 v151, v151
  v_rcp_f32 v152, v152
  v_rcp_f32 v153, v153
  v_rcp_f32 v154, v154
  v_rcp_f32 v155, v155
  v_pk_mul_f32 v[20:21], v[20:21], v[144:145]
  v_pk_mul_f32 v[22:23], v[22:23], v[146:147]
  v_pk_mul_f32 v[36:37], v[36:37], v[148:149]
  v_pk_mul_f32 v[38:39], v[38:39], v[150:151]
  v_pk_mul_f32 v[52:53], v[52:53], v[152:153]
  v_pk_mul_f32 v[54:55], v[54:55], v[154:155]
  v_cvt_pk_bf16_f32 v168, v20, v21
  v_cvt_pk_bf16_f32 v169, v22, v23
  v_cvt_pk_bf16_f32 v170, v36, v37
  v_cvt_pk_bf16_f32 v171, v38, v39
  v_cvt_pk_bf16_f32 v178, v52, v53
  v_cvt_pk_bf16_f32 v179, v54, v55
  buffer_store_dwordx4 v[168:171], v255, s[36:39], s29 offen offset:3072 sc1
  buffer_store_dwordx4 v[176:179], v208, s[36:39], s30 offen offset:1024 sc1
  s_waitcnt vmcnt(4)
  s_mov_b64 exec, 3
  v_cmp_ne_u32 vcc, s55, v233
  s_mov_b64 exec, -1
  s_cbranch_vccz L_pok_9

  s_mov_b32 s60, 0
  s_mov_b64 exec, 0x3
L_poll_10:
  buffer_load_dword v3, v232, s[36:39], s14 offen sc1
  s_add_u32 s60, s60, 1
  s_waitcnt vmcnt(0)
  v_cmp_ne_u32 vcc, s55, v3
  s_mov_b64 exec, vcc
  s_cbranch_execz L_pdone_11
  s_cmp_lt_u32 s60, 40000
  s_cbranch_scc1 L_poll_10
L_pdone_11:
  s_mov_b64 exec, -1
L_pok_9:
  s_add_u32 s11, s28, 0
  buffer_load_dwordx4 a[0:3], v255, s[36:39], s11 offen offset:0 sc1
  buffer_load_dwordx4 a[4:7], v255, s[36:39], s11 offen offset:1024 sc1
  s_add_u32 s11, s28, 4096
  buffer_load_dwordx4 a[8:11], v255, s[36:39], s11 offen offset:0 sc1
  buffer_load_dwordx4 a[12:15], v255, s[36:39], s11 offen offset:1024 sc1
  s_add_u32 s11, s28, 8192
  buffer_load_dwordx4 a[16:19], v255, s[36:39], s11 offen offset:0 sc1
  buffer_load_dwordx4 a[20:23], v255, s[36:39], s11 offen offset:1024 sc1
  s_add_u32 s11, s28, 12288
  buffer_load_dwordx4 a[24:27], v255, s[36:39], s11 offen offset:0 sc1
  buffer_load_dwordx4 a[28:31], v255, s[36:39], s11 offen offset:1024 sc1
  s_add_u32 s11, s28, 16384
  buffer_load_dwordx4 a[32:35], v255, s[36:39], s11 offen offset:0 sc1
  buffer_load_dwordx4 a[36:39], v255, s[36:39], s11 offen offset:1024 sc1
  v_lshlrev_b32 v0, 16, v180
  v_and_b32 v1, s9, v180
  v_lshlrev_b32 v6, 16, v181
  v_and_b32 v7, s9, v181
  v_lshlrev_b32 v188, 16, v182
  v_and_b32 v189, s9, v182
  v_lshlrev_b32 v190, 16, v183
  v_and_b32 v191, s9, v183
  v_lshlrev_b32 v192, 16, v184
  v_and_b32 v193, s9, v184
  v_lshlrev_b32 v194, 16, v185
  v_and_b32 v195, s9, v185
  v_lshlrev_b32 v196, 16, v186
  v_and_b32 v197, s9, v186
  v_lshlrev_b32 v198, 16, v187
  v_and_b32 v199, s9, v187
  v_mov_b32 v184, v0
  v_mov_b32 v185, v1
  v_mov_b32 v186, v6
  v_mov_b32 v187, v7
  s_lshl_b32 s61, s56, 7
  s_add_u32 s61, s61, 0xe88000
  v_mov_b32 v3, s55
  v_lshlrev_b32 v2, 15, v4

  s_waitcnt vmcnt(10)
  s_cmp_lg_u32 s54, 0
  s_barrier
  s_cbranch_scc1 L_nofl_12
  s_mov_b64 exec, 1
  buffer_store_dword v3, v2, s[36:39], s61 offen sc1

  s_mov_b64 exec, -1
L_nofl_12:
  s_waitcnt vmcnt(8)
  v_mfma_f32_16x16x32_bf16 v[8:11], a[192:195], a[0:3], v[184:187]
  s_add_u32 s11, s28, 20480
  buffer_load_dwordx4 a[40:43], v255, s[36:39], s11 offen offset:0 sc1
  v_mfma_f32_16x16x32_bf16 v[24:27], a[196:199], a[0:3], 0
  v_mfma_f32_16x16x32_bf16 v[40:43], a[200:203], a[0:3], 0
  v_mfma_f32_16x16x32_bf16 v[56:59], a[204:207], a[0:3], 0
  v_mfma_f32_16x16x32_bf16 v[12:15], a[192:195], a[4:7], v[188:191]
  buffer_load_dwordx4 a[44:47], v255, s[36:39], s11 offen offset:1024 sc1
  v_mfma_f32_16x16x32_bf16 v[28:31], a[196:199], a[4:7], 0
  v_mfma_f32_16x16x32_bf16 v[44:47], a[200:203], a[4:7], 0
  v_mfma_f32_16x16x32_bf16 v[60:63], a[204:207], a[4:7], 0
  s_waitcnt vmcnt(8)
  v_mfma_f32_16x16x32_bf16 v[8:11], a[208:211], a[8:11], v[8:11]
  ds_read_b64_tr_b16 v[72:73], v212 offset:12288
  s_add_u32 s11, s28, 24576
  buffer_load_dwordx4 a[48:51], v255, s[36:39], s11 offen offset:0 sc1
  v_mfma_f32_16x16x32_bf16 v[24:27], a[212:215], a[8:11], v[24:27]
  ds_read_b64_tr_b16 v[74:75], v212 offset:14336
  v_mfma_f32_16x16x32_bf16 v[40:43], a[216:219], a[8:11], v[40:43]
  ds_read_b64_tr_b16 v[76:77], v213 offset:12288
  v_mfma_f32_16x16x32_bf16 v[56:59], a[220:223], a[8:11], v[56:59]
  ds_read_b64_tr_b16 v[78:79], v213 offset:14336
  v_mfma_f32_16x16x32_bf16 v[12:15], a[208:211], a[12:15], v[12:15]
  ds_read_b64_tr_b16 v[80:81], v214 offset:12288
  buffer_load_dwordx4 a[52:55], v255, s[36:39], s11 offen offset:1024 sc1
  v_mfma_f32_16x16x32_bf16 v[28:31], a[212:215], a[12:15], v[28:31]
  ds_read_b64_tr_b16 v[82:83], v214 offset:14336
  v_mfma_f32_16x16x32_bf16 v[44:47], a[216:219], a[12:15], v[44:47]
  ds_read_b64_tr_b16 v[84:85], v215 offset:12288
  v_mfma_f32_16x16x32_bf16 v[60:63], a[220:223], a[12:15], v[60:63]
  ds_read_b64_tr_b16 v[86:87], v215 offset:14336
  s_waitcnt vmcnt(8)
  v_mfma_f32_16x16x32_bf16 v[8:11], a[224:227], a[16:19], v[8:11]
  ds_read_b64_tr_b16 v[88:89], v212 offset:16384
  s_add_u32 s11, s28, 28672
  buffer_load_dwordx4 a[56:59], v255, s[36:39], s11 offen offset:0 sc1
  v_mfma_f32_16x16x32_bf16 v[24:27], a[228:231], a[16:19], v[24:27]
  ds_read_b64_tr_b16 v[90:91], v212 offset:18432
  v_mfma_f32_16x16x32_bf16 v[40:43], a[232:235], a[16:19], v[40:43]
  ds_read_b64_tr_b16 v[92:93], v213 offset:16384
  v_mfma_f32_16x16x32_bf16 v[56:59], a[236:239], a[16:19], v[56:59]
  ds_read_b64_tr_b16 v[94:95], v213 offset:18432
  v_mfma_f32_16x16x32_bf16 v[12:15], a[224:227], a[20:23], v[12:15]
  ds_read_b64_tr_b16 v[96:97], v214 offset:16384
  buffer_load_dwordx4 a[60:63], v255, s[36:39], s11 offen offset:1024 sc1
  v_mfma_f32_16x16x32_bf16 v[28:31], a[228:231], a[20:23], v[28:31]
  ds_read_b64_tr_b16 v[98:99], v214 offset:18432
  v_mfma_f32_16x16x32_bf16 v[44:47], a[232:235], a[20:23], v[44:47]
  ds_read_b64_tr_b16 v[100:101], v215 offset:16384
  v_mfma_f32_16x16x32_bf16 v[60:63], a[236:239], a[20:23], v[60:63]
  ds_read_b64_tr_b16 v[102:103], v215 offset:18432
  s_waitcnt vmcnt(8)
  s_waitcnt lgkmcnt(8)
  v_mfma_f32_16x16x32_bf16 v[8:11], v[72:75], a[24:27], v[8:11]
  ds_read_b64_tr_b16 v[104:105], v216 offset:0
  s_add_u32 s11, s28, 32768
  buffer_load_dwordx4 v[120:123], v255, s[36:39], s11 offen offset:0 sc1
  v_mfma_f32_16x16x32_bf16 v[24:27], v[76:79], a[24:27], v[24:27]
  ds_read_b64_tr_b16 v[106:107], v216 offset:2048
  v_mfma_f32_16x16x32_bf16 v[40:43], v[80:83], a[24:27], v[40:43]
  ds_read_b64_tr_b16 v[108:109], v217 offset:0
  v_mfma_f32_16x16x32_bf16 v[56:59], v[84:87], a[24:27], v[56:59]
  ds_read_b64_tr_b16 v[110:111], v217 offset:2048
  v_mfma_f32_16x16x32_bf16 v[12:15], v[72:75], a[28:31], v[12:15]
  ds_read_b64_tr_b16 v[112:113], v218 offset:0
  buffer_load_dwordx4 v[124:127], v255, s[36:39], s11 offen offset:2048 sc1
  v_mfma_f32_16x16x32_bf16 v[28:31], v[76:79], a[28:31], v[28:31]
  ds_read_b64_tr_b16 v[114:115], v218 offset:2048
  v_mfma_f32_16x16x32_bf16 v[44:47], v[80:83], a[28:31], v[44:47]
  ds_read_b64_tr_b16 v[116:117], v219 offset:0
  v_mfma_f32_16x16x32_bf16 v[60:63], v[84:87], a[28:31], v[60:63]
  ds_read_b64_tr_b16 v[118:119], v219 offset:2048
  s_waitcnt vmcnt(8)
  s_waitcnt lgkmcnt(8)
  v_mfma_f32_16x16x32_bf16 v[8:11], v[88:91], a[32:35], v[8:11]
  ds_read_b64_tr_b16 v[72:73], v216 offset:4096
  s_add_u32 s11, s28, 36864
  buffer_load_dwordx4 v[128:131], v255, s[36:39], s11 offen offset:0 sc1
  v_mfma_f32_16x16x32_bf16 v[24:27], v[92:95], a[32:35], v[24:27]
  ds_read_b64_tr_b16 v[74:75], v216 offset:6144
  v_mfma_f32_16x16x32_bf16 v[40:43], v[96:99], a[32:35], v[40:43]
  ds_read_b64_tr_b16 v[76:77], v217 offset:4096
  v_mfma_f32_16x16x32_bf16 v[56:59], v[100:103], a[32:35], v[56:59]
  ds_read_b64_tr_b16 v[78:79], v217 offset:6144
  v_mfma_f32_16x16x32_bf16 v[12:15], v[88:91], a[36:39], v[12:15]
  ds_read_b64_tr_b16 v[80:81], v218 offset:4096
  buffer_load_dwordx4 v[132:135], v255, s[36:39], s11 offen offset:2048 sc1
  v_mfma_f32_16x16x32_bf16 v[28:31], v[92:95], a[36:39], v[28:31]
  ds_read_b64_tr_b16 v[82:83], v218 offset:6144
  v_mfma_f32_16x16x32_bf16 v[44:47], v[96:99], a[36:39], v[44:47]
  ds_read_b64_tr_b16 v[84:85], v219 offset:4096
  v_mfma_f32_16x16x32_bf16 v[60:63], v[100:103], a[36:39], v[60:63]
  ds_read_b64_tr_b16 v[86:87], v219 offset:6144
  s_waitcnt vmcnt(8)
  s_waitcnt lgkmcnt(8)
  v_mfma_f32_16x16x32_bf16 v[8:11], v[104:107], a[40:43], v[8:11]
  ds_read_b64_tr_b16 v[88:89], v220 offset:0
  s_add_u32 s11, s28, 40960
  buffer_load_dwordx4 v[136:139], v255, s[36:39], s11 offen offset:0 sc1
  v_mfma_f32_16x16x32_bf16 v[24:27], v[108:111], a[40:43], v[24:27]
  ds_read_b64_tr_b16 v[90:91], v220 offset:2048
  v_mfma_f32_16x16x32_bf16 v[40:43], v[112:115], a[40:43], v[40:43]
  ds_read_b64_tr_b16 v[92:93], v221 offset:0
  v_mfma_f32_16x16x32_bf16 v[56:59], v[116:119], a[40:43], v[56:59]
  ds_read_b64_tr_b16 v[94:95], v221 offset:2048
  v_mfma_f32_16x16x32_bf16 v[12:15], v[104:107], a[44:47], v[12:15]
  ds_read_b64_tr_b16 v[96:97], v222 offset:0
  buffer_load_dwordx4 v[140:143], v255, s[36:39], s11 offen offset:2048 sc1
  v_mfma_f32_16x16x32_bf16 v[28:31], v[108:111], a[44:47], v[28:31]
  ds_read_b64_tr_b16 v[98:99], v222 offset:2048
  v_mfma_f32_16x16x32_bf16 v[44:47], v[112:115], a[44:47], v[44:47]
  ds_read_b64_tr_b16 v[100:101], v223 offset:0
  v_mfma_f32_16x16x32_bf16 v[60:63], v[116:119], a[44:47], v[60:63]
  ds_read_b64_tr_b16 v[102:103], v223 offset:2048
  s_waitcnt vmcnt(8)
  s_waitcnt lgkmcnt(8)
  v_mfma_f32_16x16x32_bf16 v[8:11], v[72:75], a[48:51], v[8:11]
  ds_read_b64_tr_b16 v[104:105], v212 offset:0
  s_mov_b64 exec, 3
  buffer_load_dword v233, v232, s[36:39], s15 offen sc1
  s_mov_b64 exec, -1
  v_mfma_f32_16x16x32_bf16 v[24:27], v[76:79], a[48:51], v[24:27]
  ds_read_b64_tr_b16 v[106:107], v212 offset:2048
  v_mfma_f32_16x16x32_bf16 v[40:43], v[80:83], a[48:51], v[40:43]
  ds_read_b64_tr_b16 v[108:109], v213 offset:0
  v_mfma_f32_16x16x32_bf16 v[56:59], v[84:87], a[48:51], v[56:59]
  ds_read_b64_tr_b16 v[110:111], v213 offset:2048
  v_mfma_f32_16x16x32_bf16 v[12:15], v[72:75], a[52:55], v[12:15]
  ds_read_b64_tr_b16 v[112:113], v214 offset:0
  v_mfma_f32_16x16x32_bf16 v[28:31], v[76:79], a[52:55], v[28:31]
  ds_read_b64_tr_b16 v[114:115], v214 offset:2048
  v_mfma_f32_16x16x32_bf16 v[44:47], v[80:83], a[52:55], v[44:47]
  ds_read_b64_tr_b16 v[116:117], v215 offset:0
  v_mfma_f32_16x16x32_bf16 v[60:63], v[84:87], a[52:55], v[60:63]
  ds_read_b64_tr_b16 v[118:119], v215 offset:2048
  s_waitcnt vmcnt(7)
  s_waitcnt lgkmcnt(8)
  v_mfma_f32_16x16x32_bf16 v[8:11], v[88:91], a[56:59], v[8:11]
  ds_read_b64_tr_b16 v[72:73], v212 offset:4096
  v_mfma_f32_16x16x32_bf16 v[24:27], v[92:95], a[56:59], v[24:27]
  ds_read_b64_tr_b16 v[74:75], v212 offset:6144
  v_mfma_f32_16x16x32_bf16 v[40:43], v[96:99], a[56:59], v[40:43]
  ds_read_b64_tr_b16 v[76:77], v213 offset:4096
  v_mfma_f32_16x16x32_bf16 v[56:59], v[100:103], a[56:59], v[56:59]
  ds_read_b64_tr_b16 v[78:79], v213 offset:6144
  v_mfma_f32_16x16x32_bf16 v[12:15], v[88:91], a[60:63], v[12:15]
  ds_read_b64_tr_b16 v[80:81], v214 offset:4096
  v_mfma_f32_16x16x32_bf16 v[28:31], v[92:95], a[60:63], v[28:31]
  ds_read_b64_tr_b16 v[82:83], v214 offset:6144
  v_mfma_f32_16x16x32_bf16 v[44:47], v[96:99], a[60:63], v[44:47]
  ds_read_b64_tr_b16 v[84:85], v215 offset:4096
  v_mfma_f32_16x16x32_bf16 v[60:63], v[100:103], a[60:63], v[60:63]
  ds_read_b64_tr_b16 v[86:87], v215 offset:6144
  s_waitcnt vmcnt(5)
  v_swap_b32 v122, v124
  v_swap_b32 v123, v125
  s_nop 0
  s_waitcnt lgkmcnt(8)
  s_nop 0
  v_mfma_f32_16x16x32_bf16 v[8:11], v[104:107], v[120:123], v[8:11]
  ds_read_b64_tr_b16 v[88:89], v212 offset:8192
  s_waitcnt vmcnt(0)
  s_mov_b64 exec, 3
  v_cmp_ne_u32 vcc, s55, v233
  s_mov_b64 exec, -1
  s_cbranch_vccz L_pok_13

  s_mov_b32 s60, 0
  s_mov_b64 exec, 0x3
L_poll_14:
  buffer_load_dword v3, v232, s[36:39], s15 offen sc1
  s_add_u32 s60, s60, 1
  s_waitcnt vmcnt(0)
  v_cmp_ne_u32 vcc, s55, v3
  s_mov_b64 exec, vcc
  s_cbranch_execz L_pdone_15
  s_cmp_lt_u32 s60, 40000
  s_cbranch_scc1 L_poll_14
L_pdone_15:
  s_mov_b64 exec, -1
L_pok_13:
  v_mfma_f32_16x16x32_bf16 v[24:27], v[108:111], v[120:123], v[24:27]
  ds_read_b64_tr_b16 v[90:91], v212 offset:10240
  s_add_u32 s11, s28, 0
  buffer_load_dwordx4 a[64:67], v255, s[36:39], s11 offen offset:2048 sc1
  v_mfma_f32_16x16x32_bf16 v[40:43], v[112:115], v[120:123], v[40:43]
  ds_read_b64_tr_b16 v[92:93], v213 offset:8192
  v_mfma_f32_16x16x32_bf16 v[56:59], v[116:119], v[120:123], v[56:59]
  ds_read_b64_tr_b16 v[94:95], v213 offset:10240
  buffer_load_dwordx4 a[68:71], v255, s[36:39], s11 offen offset:3072 sc1
  v_mfma_f32_16x16x32_bf16 v[12:15], v[104:107], v[124:127], v[12:15]
  ds_read_b64_tr_b16 v[96:97], v214 offset:8192
  v_mfma_f32_16x16x32_bf16 v[28:31], v[108:111], v[124:127], v[28:31]
  ds_read_b64_tr_b16 v[98:99], v214 offset:10240
  s_add_u32 s11, s28, 4096
  buffer_load_dwordx4 a[72:75], v255, s[36:39], s11 offen offset:2048 sc1
  v_mfma_f32_16x16x32_bf16 v[44:47], v[112:115], v[124:127], v[44:47]
  ds_read_b64_tr_b16 v[100:101], v215 offset:8192
  v_mfma_f32_16x16x32_bf16 v[60:63], v[116:119], v[124:127], v[60:63]
  ds_read_b64_tr_b16 v[102:103], v215 offset:10240
  buffer_load_dwordx4 a[76:79], v255, s[36:39], s11 offen offset:3072 sc1
  v_swap_b32 v130, v132
  v_swap_b32 v131, v133
  s_nop 0
  s_waitcnt lgkmcnt(8)
  s_nop 0
  v_mfma_f32_16x16x32_bf16 v[8:11], v[72:75], v[128:131], v[8:11]
  v_mfma_f32_16x16x32_bf16 v[24:27], v[76:79], v[128:131], v[24:27]
  s_add_u32 s11, s28, 8192
  buffer_load_dwordx4 a[80:83], v255, s[36:39], s11 offen offset:2048 sc1
  v_mfma_f32_16x16x32_bf16 v[40:43], v[80:83], v[128:131], v[40:43]
  v_mfma_f32_16x16x32_bf16 v[56:59], v[84:87], v[128:131], v[56:59]
  buffer_load_dwordx4 a[84:87], v255, s[36:39], s11 offen offset:3072 sc1
  v_mfma_f32_16x16x32_bf16 v[12:15], v[72:75], v[132:135], v[12:15]
  v_mfma_f32_16x16x32_bf16 v[28:31], v[76:79], v[132:135], v[28:31]
  s_add_u32 s11, s28, 12288
  buffer_load_dwordx4 a[88:91], v255, s[36:39], s11 offen offset:2048 sc1
  v_mfma_f32_16x16x32_bf16 v[44:47], v[80:83], v[132:135], v[44:47]
  v_mfma_f32_16x16x32_bf16 v[60:63], v[84:87], v[132:135], v[60:63]
  buffer_load_dwordx4 a[92:95], v255, s[36:39], s11 offen offset:3072 sc1
  v_swap_b32 v138, v140
  v_swap_b32 v139, v141
  s_nop 0
  s_waitcnt lgkmcnt(0)
  s_nop 0
  v_mfma_f32_16x16x32_bf16 v[8:11], v[88:91], v[136:139], v[8:11]
  v_mfma_f32_16x16x32_bf16 v[24:27], v[92:95], v[136:139], v[24:27]
  s_add_u32 s11, s28, 16384
  buffer_load_dwordx4 a[96:99], v255, s[36:39], s11 offen offset:2048 sc1
  v_mfma_f32_16x16x32_bf16 v[40:43], v[96:99], v[136:139], v[40:43]
  v_mfma_f32_16x16x32_bf16 v[56:59], v[100:103], v[136:139], v[56:59]
  buffer_load_dwordx4 a[100:103], v255, s[36:39], s11 offen offset:3072 sc1
  v_mfma_f32_16x16x32_bf16 v[12:15], v[88:91], v[140:143], v[12:15]
  v_mfma_f32_16x16x32_bf16 v[28:31], v[92:95], v[140:143], v[28:31]
  s_add_u32 s11, s28, 20480
  buffer_load_dwordx4 a[104:107], v255, s[36:39], s11 offen offset:2048 sc1
  v_mfma_f32_16x16x32_bf16 v[44:47], v[96:99], v[140:143], v[44:47]
  v_mfma_f32_16x16x32_bf16 v[60:63], v[100:103], v[140:143], v[60:63]
  s_waitcnt vmcnt(9)
  v_mfma_f32_16x16x32_bf16 v[16:19], a[192:195], a[64:67], v[192:195]
  v_mfma_f32_16x16x32_bf16 v[32:35], a[196:199], a[64:67], 0
  buffer_load_dwordx4 a[108:111], v255, s[36:39], s11 offen offset:3072 sc1
  v_mfma_f32_16x16x32_bf16 v[48:51], a[200:203], a[64:67], 0
  v_mfma_f32_16x16x32_bf16 v[64:67], a[204:207], a[64:67], 0
  v_mfma_f32_16x16x32_bf16 v[20:23], a[192:195], a[68:71], v[196:199]
  v_mfma_f32_16x16x32_bf16 v[36:39], a[196:199], a[68:71], 0
  s_add_u32 s11, s28, 24576
  buffer_load_dwordx4 a[112:115], v255, s[36:39], s11 offen offset:2048 sc1
  v_mfma_f32_16x16x32_bf16 v[52:55], a[200:203], a[68:71], 0
  v_mfma_f32_16x16x32_bf16 v[68:71], a[204:207], a[68:71], 0
  s_waitcnt vmcnt(9)
  v_mfma_f32_16x16x32_bf16 v[16:19], a[208:211], a[72:75], v[16:19]
  ds_read_b64_tr_b16 v[104:105], v212 offset:12288
  ds_write_b128 v228, v[24:27] offset:0
  v_mfma_f32_16x16x32_bf16 v[32:35], a[212:215], a[72:75], v[32:35]
  ds_read_b64_tr_b16 v[106:107], v212 offset:14336
  buffer_load_dwordx4 a[116:119], v255, s[36:39], s11 offen offset:3072 sc1
  v_mfma_f32_16x16x32_bf16 v[48:51], a[216:219], a[72:75], v[48:51]
  ds_read_b64_tr_b16 v[108:109], v213 offset:12288
  ds_write_b128 v228, v[28:31] offset:1024
  v_mfma_f32_16x16x32_bf16 v[64:67], a[220:223], a[72:75], v[64:67]
  ds_read_b64_tr_b16 v[110:111], v213 offset:14336
  v_mfma_f32_16x16x32_bf16 v[20:23], a[208:211], a[76:79], v[20:23]
  ds_read_b64_tr_b16 v[112:113], v214 offset:12288
  ds_write_b128 v228, v[40:43] offset:2048
  v_mfma_f32_16x16x32_bf16 v[36:39], a[212:215], a[76:79], v[36:39]
  ds_read_b64_tr_b16 v[114:115], v214 offset:14336
  s_add_u32 s11, s28, 28672
  buffer_load_dwordx4 a[120:123], v255, s[36:39], s11 offen offset:2048 sc1
  v_mfma_f32_16x16x32_bf16 v[52:55], a[216:219], a[76:79], v[52:55]
  ds_read_b64_tr_b16 v[116:117], v215 offset:12288
  ds_write_b128 v228, v[44:47] offset:3072
  v_mfma_f32_16x16x32_bf16 v[68:71], a[220:223], a[76:79], v[68:71]
  ds_read_b64_tr_b16 v[118:119], v215 offset:14336
  s_waitcnt vmcnt(9)
  v_mfma_f32_16x16x32_bf16 v[16:19], a[224:227], a[80:83], v[16:19]
  ds_read_b64_tr_b16 v[72:73], v212 offset:16384
  ds_write_b128 v228, v[56:59] offset:4096
  v_mfma_f32_16x16x32_bf16 v[32:35], a[228:231], a[80:83], v[32:35]
  ds_read_b64_tr_b16 v[74:75], v212 offset:18432
  buffer_load_dwordx4 a[124:127], v255, s[36:39], s11 offen offset:3072 sc1
  v_mfma_f32_16x16x32_bf16 v[48:51], a[232:235], a[80:83], v[48:51]
  ds_read_b64_tr_b16 v[76:77], v213 offset:16384
  ds_write_b128 v228, v[60:63] offset:5120
  v_mfma_f32_16x16x32_bf16 v[64:67], a[236:239], a[80:83], v[64:67]
  ds_read_b64_tr_b16 v[78:79], v213 offset:18432
  v_mfma_f32_16x16x32_bf16 v[20:23], a[224:227], a[84:87], v[20:23]
  ds_read_b64_tr_b16 v[80:81], v214 offset:16384
  v_mfma_f32_16x16x32_bf16 v[36:39], a[228:231], a[84:87], v[36:39]
  ds_read_b64_tr_b16 v[82:83], v214 offset:18432
  s_add_u32 s11, s28, 32768
  buffer_load_dwordx4 v[144:147], v255, s[36:39], s11 offen offset:1024 sc1
  v_mfma_f32_16x16x32_bf16 v[52:55], a[232:235], a[84:87], v[52:55]
  ds_read_b64_tr_b16 v[84:85], v215 offset:16384
  v_mfma_f32_16x16x32_bf16 v[68:71], a[236:239], a[84:87], v[68:71]
  ds_read_b64_tr_b16 v[86:87], v215 offset:18432
  s_waitcnt vmcnt(9)
  s_waitcnt lgkmcnt(10)
  v_mfma_f32_16x16x32_bf16 v[16:19], v[104:107], a[88:91], v[16:19]
  ds_read_b64_tr_b16 v[88:89], v216 offset:0
  v_mfma_f32_16x16x32_bf16 v[32:35], v[108:111], a[88:91], v[32:35]
  ds_read_b64_tr_b16 v[90:91], v216 offset:2048
  buffer_load_dwordx4 v[148:151], v255, s[36:39], s11 offen offset:3072 sc1
  v_mfma_f32_16x16x32_bf16 v[48:51], v[112:115], a[88:91], v[48:51]
  ds_read_b64_tr_b16 v[92:93], v217 offset:0
  s_waitcnt lgkmcnt(8)
  s_barrier
  ds_read_b128 v[120:123], v225 offset:0
  v_mfma_f32_16x16x32_bf16 v[64:67], v[116:119], a[88:91], v[64:67]
  ds_read_b64_tr_b16 v[94:95], v217 offset:2048
  ds_read_b128 v[124:127], v225 offset:1024
  v_mfma_f32_16x16x32_bf16 v[20:23], v[104:107], a[92:95], v[20:23]
  ds_read_b64_tr_b16 v[96:97], v218 offset:0
  ds_read_b128 v[128:131], v226 offset:2048
  v_mfma_f32_16x16x32_bf16 v[36:39], v[108:111], a[92:95], v[36:39]
  ds_read_b64_tr_b16 v[98:99], v218 offset:2048
  s_add_u32 s11, s28, 36864
  buffer_load_dwordx4 v[152:155], v255, s[36:39], s11 offen offset:1024 sc1
  ds_read_b128 v[132:135], v226 offset:3072
  v_mfma_f32_16x16x32_bf16 v[52:55], v[112:115], a[92:95], v[52:55]
  ds_read_b64_tr_b16 v[100:101], v219 offset:0
  ds_read_b128 v[136:139], v227 offset:4096
  v_mfma_f32_16x16x32_bf16 v[68:71], v[116:119], a[92:95], v[68:71]
  ds_read_b64_tr_b16 v[102:103], v219 offset:2048
  ds_read_b128 v[140:143], v227 offset:5120
  s_waitcnt vmcnt(9)
  s_waitcnt lgkmcnt(14)
  v_mfma_f32_16x16x32_bf16 v[16:19], v[72:75], a[96:99], v[16:19]
  ds_read_b64_tr_b16 v[104:105], v216 offset:4096
  v_mfma_f32_16x16x32_bf16 v[32:35], v[76:79], a[96:99], v[32:35]
  ds_read_b64_tr_b16 v[106:107], v216 offset:6144
  buffer_load_dwordx4 v[156:159], v255, s[36:39], s11 offen offset:3072 sc1
  v_mfma_f32_16x16x32_bf16 v[48:51], v[80:83], a[96:99], v[48:51]
  ds_read_b64_tr_b16 v[108:109], v217 offset:4096
  v_mfma_f32_16x16x32_bf16 v[64:67], v[84:87], a[96:99], v[64:67]
  ds_read_b64_tr_b16 v[110:111], v217 offset:6144
  v_mfma_f32_16x16x32_bf16 v[20:23], v[72:75], a[100:103], v[20:23]
  ds_read_b64_tr_b16 v[112:113], v218 offset:4096
  v_mfma_f32_16x16x32_bf16 v[36:39], v[76:79], a[100:103], v[36:39]
  ds_read_b64_tr_b16 v[114:115], v218 offset:6144
  s_add_u32 s11, s28, 40960
  buffer_load_dwordx4 v[160:163], v255, s[36:39], s11 offen offset:1024 sc1
  v_mfma_f32_16x16x32_bf16 v[52:55], v[80:83], a[100:103], v[52:55]
  ds_read_b64_tr_b16 v[116:117], v219 offset:4096
  s_waitcnt lgkmcnt(15)
  v_add_f32 v8, v8, v120
  v_mfma_f32_16x16x32_bf16 v[68:71], v[84:87], a[100:103], v[68:71]
  ds_read_b64_tr_b16 v[118:119], v219 offset:6144
  v_add_f32 v9, v9, v121
  v_add_f32 v10, v10, v122
  s_waitcnt vmcnt(9)
  s_waitcnt lgkmcnt(9)
  v_mfma_f32_16x16x32_bf16 v[16:19], v[88:91], a[104:107], v[16:19]
  ds_read_b64_tr_b16 v[72:73], v220 offset:0
  v_add_f32 v11, v11, v123
  v_add_f32 v12, v12, v124
  v_mfma_f32_16x16x32_bf16 v[32:35], v[92:95], a[104:107], v[32:35]
  ds_read_b64_tr_b16 v[74:75], v220 offset:2048
  buffer_load_dwordx4 v[164:167], v255, s[36:39], s11 offen offset:3072 sc1
  v_add_f32 v13, v13, v125
  v_add_f32 v14, v14, v126
  v_mfma_f32_16x16x32_bf16 v[48:51], v[96:99], a[104:107], v[48:51]
  ds_read_b64_tr_b16 v[76:77], v221 offset:0
  v_add_f32 v15, v15, v127
  v_mfma_f32_16x16x32_bf16 v[64:67], v[100:103], a[104:107], v[64:67]
  ds_read_b64_tr_b16 v[78:79], v221 offset:2048
  v_add_f32 v8, v8, v128
  v_add_f32 v9, v9, v129
  v_mfma_f32_16x16x32_bf16 v[20:23], v[88:91], a[108:111], v[20:23]
  ds_read_b64_tr_b16 v[80:81], v222 offset:0
  v_add_f32 v10, v10, v130
  v_add_f32 v11, v11, v131
  v_mfma_f32_16x16x32_bf16 v[36:39], v[92:95], a[108:111], v[36:39]
  ds_read_b64_tr_b16 v[82:83], v222 offset:2048
  v_add_f32 v12, v12, v132
  v_add_f32 v13, v13, v133
  v_mfma_f32_16x16x32_bf16 v[52:55], v[96:99], a[108:111], v[52:55]
  ds_read_b64_tr_b16 v[84:85], v223 offset:0
  v_add_f32 v14, v14, v134
  v_add_f32 v15, v15, v135
  v_mfma_f32_16x16x32_bf16 v[68:71], v[100:103], a[108:111], v[68:71]
  ds_read_b64_tr_b16 v[86:87], v223 offset:2048
  s_waitcnt lgkmcnt(15)
  v_add_f32 v8, v8, v136
  s_waitcnt vmcnt(8)
  s_waitcnt lgkmcnt(8)
  v_mfma_f32_16x16x32_bf16 v[16:19], v[104:107], a[112:115], v[16:19]
  ds_read_b64_tr_b16 v[88:89], v212 offset:0
  v_add_f32 v9, v9, v137
  v_add_f32 v10, v10, v138
  v_mfma_f32_16x16x32_bf16 v[32:35], v[108:111], a[112:115], v[32:35]
  ds_read_b64_tr_b16 v[90:91], v212 offset:2048
  v_add_f32 v11, v11, v139
  v_add_f32 v12, v12, v140
  v_mfma_f32_16x16x32_bf16 v[48:51], v[112:115], a[112:115], v[48:51]
  ds_read_b64_tr_b16 v[92:93], v213 offset:0
  v_add_f32 v13, v13, v141
  v_add_f32 v14, v14, v142
  v_mfma_f32_16x16x32_bf16 v[64:67], v[116:119], a[112:115], v[64:67]
  ds_read_b64_tr_b16 v[94:95], v213 offset:2048
  v_add_f32 v15, v15, v143
  v_cvt_pk_bf16_f32 v180, v8, v9
  v_mfma_f32_16x16x32_bf16 v[20:23], v[104:107], a[116:119], v[20:23]
  ds_read_b64_tr_b16 v[96:97], v214 offset:0
  v_cvt_pk_bf16_f32 v181, v10, v11
  v_cvt_pk_bf16_f32 v182, v12, v13
  v_mfma_f32_16x16x32_bf16 v[36:39], v[108:111], a[116:119], v[36:39]
  ds_read_b64_tr_b16 v[98:99], v214 offset:2048
  v_cvt_pk_bf16_f32 v183, v14, v15
  s_nop 1
  v_mfma_f32_16x16x32_bf16 v[52:55], v[112:115], a[116:119], v[52:55]
  ds_read_b64_tr_b16 v[100:101], v215 offset:0
  v_permlane16_swap_b32 v180, v182
  v_permlane16_swap_b32 v181, v183
  v_mfma_f32_16x16x32_bf16 v[68:71], v[116:119], a[116:119], v[68:71]
  ds_read_b64_tr_b16 v[102:103], v215 offset:2048
  buffer_store_dwordx4 v[180:183], v224, s[48:51], s12 offen
  s_waitcnt vmcnt(7)
  s_waitcnt lgkmcnt(8)
  v_mfma_f32_16x16x32_bf16 v[16:19], v[72:75], a[120:123], v[16:19]
  ds_read_b64_tr_b16 v[104:105], v212 offset:4096
  v_mfma_f32_16x16x32_bf16 v[32:35], v[76:79], a[120:123], v[32:35]
  ds_read_b64_tr_b16 v[106:107], v212 offset:6144
  v_mfma_f32_16x16x32_bf16 v[48:51], v[80:83], a[120:123], v[48:51]
  ds_read_b64_tr_b16 v[108:109], v213 offset:4096
  v_mfma_f32_16x16x32_bf16 v[64:67], v[84:87], a[120:123], v[64:67]
  ds_read_b64_tr_b16 v[110:111], v213 offset:6144
  v_mfma_f32_16x16x32_bf16 v[20:23], v[72:75], a[124:127], v[20:23]
  ds_read_b64_tr_b16 v[112:113], v214 offset:4096
  v_mfma_f32_16x16x32_bf16 v[36:39], v[76:79], a[124:127], v[36:39]
  ds_read_b64_tr_b16 v[114:115], v214 offset:6144
  v_mfma_f32_16x16x32_bf16 v[52:55], v[80:83], a[124:127], v[52:55]
  ds_read_b64_tr_b16 v[116:117], v215 offset:4096
  v_mfma_f32_16x16x32_bf16 v[68:71], v[84:87], a[124:127], v[68:71]
  ds_read_b64_tr_b16 v[118:119], v215 offset:6144
  ds_read_b64_tr_b16 v[72:73], v212 offset:8192
  ds_read_b64_tr_b16 v[74:75], v212 offset:10240
  ds_read_b64_tr_b16 v[76:77], v213 offset:8192
  ds_read_b64_tr_b16 v[78:79], v213 offset:10240
  ds_read_b64_tr_b16 v[80:81], v214 offset:8192
  ds_read_b64_tr_b16 v[82:83], v214 offset:10240
  ds_read_b64_tr_b16 v[84:85], v215 offset:8192
  ds_read_b64_tr_b16 v[86:87], v215 offset:10240
  s_barrier
  s_waitcnt vmcnt(3)
  v_swap_b32 v146, v148
  v_swap_b32 v147, v149
  v_swap_b32 v154, v156
  v_swap_b32 v155, v157
  s_waitcnt lgkmcnt(8)
  s_nop 0
  v_mfma_f32_16x16x32_bf16 v[32:35], v[92:95], v[144:147], v[32:35]
  v_mfma_f32_16x16x32_bf16 v[36:39], v[92:95], v[148:151], v[36:39]
  s_waitcnt vmcnt(1)
  v_swap_b32 v162, v164
  v_swap_b32 v163, v165
  v_mfma_f32_16x16x32_bf16 v[32:35], v[108:111], v[152:155], v[32:35]
  v_mfma_f32_16x16x32_bf16 v[36:39], v[108:111], v[156:159], v[36:39]
  s_waitcnt lgkmcnt(0)
  v_mfma_f32_16x16x32_bf16 v[32:35], v[76:79], v[160:163], v[32:35]
  v_mfma_f32_16x16x32_bf16 v[36:39], v[76:79], v[164:167], v[36:39]
  v_mfma_f32_16x16x32_bf16 v[48:51], v[96:99], v[144:147], v[48:51]
  v_mfma_f32_16x16x32_bf16 v[52:55], v[96:99], v[148:151], v[52:55]
  v_mfma_f32_16x16x32_bf16 v[48:51], v[112:115], v[152:155], v[48:51]
  v_mfma_f32_16x16x32_bf16 v[52:55], v[112:115], v[156:159], v[52:55]
  v_mfma_f32_16x16x32_bf16 v[48:51], v[80:83], v[160:163], v[48:51]
  v_mfma_f32_16x16x32_bf16 v[52:55], v[80:83], v[164:167], v[52:55]
  v_mfma_f32_16x16x32_bf16 v[64:67], v[100:103], v[144:147], v[64:67]
  ds_write_b128 v228, v[32:35] offset:0
  v_mfma_f32_16x16x32_bf16 v[68:71], v[100:103], v[148:151], v[68:71]
  ds_write_b128 v228, v[36:39] offset:1024
  v_mfma_f32_16x16x32_bf16 v[64:67], v[116:119], v[152:155], v[64:67]
  v_mfma_f32_16x16x32_bf16 v[68:71], v[116:119], v[156:159], v[68:71]
  v_mfma_f32_16x16x32_bf16 v[64:67], v[84:87], v[160:163], v[64:67]
  v_mfma_f32_16x16x32_bf16 v[68:71], v[84:87], v[164:167], v[68:71]
  v_mfma_f32_16x16x32_bf16 v[16:19], v[88:91], v[144:147], v[16:19]
  ds_write_b128 v228, v[48:51] offset:2048
  v_mfma_f32_16x16x32_bf16 v[20:23], v[88:91], v[148:151], v[20:23]
  ds_write_b128 v228, v[52:55] offset:3072
  v_mfma_f32_16x16x32_bf16 v[16:19], v[104:107], v[152:155], v[16:19]
  v_mfma_f32_16x16x32_bf16 v[20:23], v[104:107], v[156:159], v[20:23]
  v_mfma_f32_16x16x32_bf16 v[16:19], v[72:75], v[160:163], v[16:19]
  v_mfma_f32_16x16x32_bf16 v[20:23], v[72:75], v[164:167], v[20:23]
  s_nop 0
  ds_write_b128 v228, v[64:67] offset:4096
  ds_write_b128 v228, v[68:71] offset:5120
  s_waitcnt lgkmcnt(0)
  s_barrier
  ds_read_b128 v[120:123], v225 offset:0
  ds_read_b128 v[124:127], v225 offset:1024
  ds_read_b128 v[128:131], v226 offset:2048
  ds_read_b128 v[132:135], v226 offset:3072
  ds_read_b128 v[136:139], v227 offset:4096
  ds_read_b128 v[140:143], v227 offset:5120
  s_waitcnt lgkmcnt(4)
  v_add_f32 v16, v16, v120
  v_add_f32 v17, v17, v121
  v_add_f32 v18, v18, v122
  v_add_f32 v19, v19, v123
  v_add_f32 v20, v20, v124
  v_add_f32 v21, v21, v125
  v_add_f32 v22, v22, v126
  v_add_f32 v23, v23, v127
  s_waitcnt lgkmcnt(2)
  v_add_f32 v16, v16, v128
  v_add_f32 v17, v17, v129
  v_add_f32 v18, v18, v130
  v_add_f32 v19, v19, v131
  v_add_f32 v20, v20, v132
  v_add_f32 v21, v21, v133
  v_add_f32 v22, v22, v134
  v_add_f32 v23, v23, v135
  s_waitcnt lgkmcnt(0)
  v_add_f32 v16, v16, v136
  v_add_f32 v17, v17, v137
  v_add_f32 v18, v18, v138
  v_add_f32 v19, v19, v139
  v_add_f32 v20, v20, v140
  v_add_f32 v21, v21, v141
  v_add_f32 v22, v22, v142
  v_add_f32 v23, v23, v143
  v_cvt_pk_bf16_f32 v180, v16, v17
  v_cvt_pk_bf16_f32 v181, v18, v19
  v_cvt_pk_bf16_f32 v182, v20, v21
  v_cvt_pk_bf16_f32 v183, v22, v23
  s_nop 1
  v_permlane16_swap_b32 v180, v182
  v_permlane16_swap_b32 v181, v183
  buffer_store_dwordx4 v[180:183], v224, s[48:51], s31 offen
L_end:
  s_endpgm
L_code_end:
.section .rodata,"a"
.p2align 6
.amdhsa_kernel sequential_preLN__ssm_conv_h3__dense_activation_silu__prompt_kernel
  .amdhsa_next_free_vgpr 512
  .amdhsa_next_free_sgpr 102
  .amdhsa_accum_offset 256
  .amdhsa_group_segment_fixed_size 0
  .amdhsa_kernarg_size 96
  .amdhsa_user_sgpr_count 2
  .amdhsa_user_sgpr_kernarg_segment_ptr 1
  .amdhsa_system_sgpr_workgroup_id_x 1
.end_amdhsa_kernel
```
